```python
import torch

def _softmax(x, axis=-1):
    return torch.softmax(x, dim=axis)
def _gelu(x):
    return torch.nn.functional.gelu(x, approximate="tanh")
def _silu(x):
    return torch.nn.functional.silu(x)
def _sigmoid(x):
    return torch.sigmoid(x)
def _layernorm(x, axis=-1, eps=1e-5):
    m = x.mean(dim=axis, keepdim=True)
    v = x.var(dim=axis, keepdim=True, unbiased=False)
    return (x - m) / torch.sqrt(v + eps)
def _scatter_add(tgt, idx, src, axis=0):
    return tgt.clone().index_add_(axis, idx, src)
def _segment_sum(src, seg, n):
    out = torch.zeros((n,) + src.shape[1:], dtype=src.dtype)
    return out.index_add_(0, seg, src)
def _pad(x, pw):
    flat = tuple(v for pair in reversed(pw) for v in pair)
    return torch.nn.functional.pad(x, flat)

kernel_name = 'concat_heads__mha_block_cached__compressed_kv_cla__decode'

def setup_inputs():

    _w = (lambda a: (lambda t: t.to(torch.bfloat16) if t.is_floating_point() else t)(torch.as_tensor(a)))
    def _A_setup():
        B, Sq, D = 2, 1, 448
        H, Sk, Dh = 16, 4096, 256
        return {
            "x": _w((lambda *s: torch.randn(*s, dtype=torch.bfloat16) * 1.6)(B, Sq, D)),
            "k_cache": _w((lambda *s: torch.randn(*s, dtype=torch.bfloat16) * 1.6)(B, H, Sk, Dh)),
            "v_cache": _w((lambda *s: torch.randn(*s, dtype=torch.bfloat16) * 0.05)(B, H, Sk, Dh)),
            "wq": _w((lambda *s: torch.randn(*s, dtype=torch.bfloat16) * 1.6)(D, H * Dh) * (D ** -0.5)),
            "wo": _w((lambda *s: torch.randn(*s, dtype=torch.bfloat16) * 0.05)(H * Dh, D) * ((H * Dh) ** -0.5)),
        }
    _A_in = _A_setup()

    def _B_setup():
        B, H, Sq, Sk, D, M = 2, 16, 1, 4096, 256, 448
        Dc = 4 * D
        return {
            "x": _w((lambda *s: torch.randn(*s, dtype=torch.bfloat16) * 3.2)(B, Sq, M)),
            "c_kv": _w((lambda *s: torch.randn(*s, dtype=torch.bfloat16) * 0.1)(B, Sk, Dc)),
            "w_q": _w((lambda *s: torch.randn(*s, dtype=torch.bfloat16) * 6.4)(M, H, D) * (M ** -0.5)),
            "w_uk": _w((lambda *s: torch.randn(*s, dtype=torch.bfloat16) * 6.4)(Dc, H, D) * (Dc ** -0.5)),
            "w_uv": _w((lambda *s: torch.randn(*s, dtype=torch.bfloat16) * 0.1)(Dc, H, D) * (Dc ** -0.5)),
            "w_o": _w((lambda *s: torch.randn(*s, dtype=torch.bfloat16) * 0.1)(H, D, M) * ((H * D) ** -0.5)),
        }
    _B_in = _B_setup()

    return {
        "A_x": _A_in["x"],
        "A_k_cache": _A_in["k_cache"],
        "A_v_cache": _A_in["v_cache"],
        "A_wq": _A_in["wq"],
        "A_wo": _A_in["wo"],
        "B_x": _B_in["x"],
        "B_c_kv": _B_in["c_kv"],
        "B_w_q": _B_in["w_q"],
        "B_w_uk": _B_in["w_uk"],
        "B_w_uv": _B_in["w_uv"],
        "B_w_o": _B_in["w_o"],
    }

def reference(A_x, A_k_cache, A_v_cache, A_wq, A_wo, B_x, B_c_kv, B_w_q, B_w_uk, B_w_uv, B_w_o):
    def _A_ref(x, k_cache, v_cache, wq, wo):
        B, Sq, D = x.shape
        H, Dh = 16, 256
        q = (lambda x, *d: x.permute(*d))((x @ wq).reshape(B, Sq, H, Dh), 0, 2, 1, 3)
        scores = torch.einsum("bhqd,bhkd->bhqk", q, k_cache) * (Dh ** -0.5)
        p = _softmax(scores, axis=-1)
        o = torch.einsum("bhqk,bhkd->bhqd", p, v_cache)
        return (lambda x, *d: x.permute(*d))(o, 0, 2, 1, 3).reshape(B, Sq, H * Dh) @ wo

    def _B_ref(x, c_kv, w_q, w_uk, w_uv, w_o):
        B, Sq, M = x.shape[0], x.shape[1], x.shape[2]
        Sk = c_kv.shape[1]
        H, D = w_q.shape[1], w_q.shape[2]
        q = torch.einsum("bqm,mhd->bhqd", x, w_q)
        k = torch.einsum("bkc,chd->bhkd", c_kv, w_uk)
        v = torch.einsum("bkc,chd->bhkd", c_kv, w_uv)
        scores = torch.einsum("bhqd,bhkd->bhqk", q, k) * (D ** -0.5)
        off = Sk - Sq
        qi = torch.arange(Sq)[:, None]
        kj = torch.arange(Sk)[None, :]
        cmask = kj <= (qi + off)
        scores = torch.where(cmask[None, None], scores, -1e9)
        p = _softmax(scores, axis=-1)
        ctx = torch.einsum("bhqk,bhkd->bhqd", p, v)
        return torch.einsum("bhqd,hdm->bqm", ctx, w_o)

    a = _A_ref(A_x, A_k_cache, A_v_cache, A_wq, A_wo)
    b = _B_ref(B_x, B_c_kv, B_w_q, B_w_uk, B_w_uv, B_w_o)
    return torch.concatenate([a, b], axis=-1)
```

```asm
; @launch grid=(256,1,1) block=(512,1,1) lds=163840
.amdgcn_target "amdgcn-amd-amdhsa--gfx950"
.text
.globl concat_heads__mha_block_cached__compressed_kv_cla__decode_kernel
.p2align 8
.type concat_heads__mha_block_cached__compressed_kv_cla__decode_kernel,@function
concat_heads__mha_block_cached__compressed_kv_cla__decode_kernel:
s_cmp_ge_u32 s2, 256
s_cbranch_scc1 L_exit
v_lshrrev_b32 v8, 6, v0
v_and_b32 v1, 63, v0
v_readfirstlane_b32 s3, v8
v_and_b32 v2, 15, v1
v_lshrrev_b32 v3, 4, v1
s_and_b32 s8, s2, 7
s_lshr_b32 s9, s2, 3
s_cmp_lt_u32 s9, 8
s_cbranch_scc1 L_B1
s_cmp_lt_u32 s9, 16
s_cbranch_scc1 L_B2
s_sub_u32 s9, s9, 16
s_lshl_b32 s13, s9, 3
s_add_u32 s13, s13, s8
s_lshr_b32 s10, s13, 2
s_and_b32 s4, s10, 15
s_lshr_b32 s5, s10, 4
s_and_b32 s6, s13, 3
s_mul_i32 s7, s6, 40
s_mul_i32 s10, s3, 5
s_add_u32 s7, s7, s10
s_sub_u32 s10, s3, 1
s_max_i32 s10, s10, 0
s_min_u32 s10, s10, 0
s_add_u32 s7, s7, s10
s_sub_u32 s10, s3, 1
s_cmp_lt_u32 s10, 0
s_cselect_b32 s14, 6, 5
s_load_dwordx16 s[16:31], s[0:1], 0
s_load_dwordx8 s[32:39], s[0:1], 64
s_load_dwordx4 s[40:43], s[0:1], 96
s_lshl_b32 s7, s7, 13
s_lshl_b32 s8, s5, 4
s_add_u32 s8, s8, s4
s_lshl_b32 s9, s8, 21
v_and_b32 v8, 7, v2
v_lshlrev_b32 v5, 9, v8
v_lshrrev_b32 v8, 3, v2
v_lshl_add_u32 v5, v8, 6, v5
v_lshl_add_u32 v5, v3, 4, v5
v_lshlrev_b32 v6, 11, v3
v_lshl_add_u32 v6, v2, 4, v6
s_waitcnt lgkmcnt(0)
s_add_u32 s48, s18, s9
s_addc_u32 s49, s19, 0
s_mov_b32 s50, 0x200000
s_mov_b32 s51, 0x20000
s_add_u32 s52, s20, s9
s_addc_u32 s53, s21, 0
s_mov_b32 s54, 0x200000
s_mov_b32 s55, 0x20000
s_mov_b32 s56, s42
s_mov_b32 s57, s43
s_mov_b32 s58, 0x10000000
s_mov_b32 s59, 0x20000
s_mov_b32 s60, s40
s_mov_b32 s61, s41
s_mov_b32 s62, 0x100
s_mov_b32 s63, 0x20000
s_mov_b32 s100, 0x05040100
s_mov_b32 s101, 0x07060302
s_mov_b32 s15, 0x3db8aa3b
s_lshr_b32 s92, s13, 6
s_and_b32 s93, s13, 63
s_lshl_b32 s93, s93, 7
v_lshrrev_b32 v10, 3, v1
v_and_b32 v11, 7, v1
v_lshlrev_b32 v4, 13, v10
v_lshl_add_u32 v4, v11, 4, v4
v_lshlrev_b32 v7, 1, v10
s_cmp_eq_u32 s92, 1
s_cselect_b32 s44, s30, s22
s_cselect_b32 s45, s31, s23
s_mov_b32 s46, 0x380000
s_mov_b32 s47, 0x20000
s_cselect_b32 s64, s26, s16
s_cselect_b32 s65, s27, s17
s_mov_b32 s66, 1792
s_mov_b32 s67, 0x20000
s_mul_i32 s12, s3, 458752
s_add_u32 s12, s12, s93
buffer_load_dwordx4 v[128:131], v4, s[44:47], s12 offen nt
s_add_u32 s12, s12, 0x10000
buffer_load_dwordx4 v[132:135], v4, s[44:47], s12 offen nt
s_add_u32 s12, s12, 0x10000
buffer_load_dwordx4 v[136:139], v4, s[44:47], s12 offen nt
s_add_u32 s12, s12, 0x10000
buffer_load_dwordx4 v[140:143], v4, s[44:47], s12 offen nt
s_add_u32 s12, s12, 0x10000
buffer_load_dwordx4 v[144:147], v4, s[44:47], s12 offen nt
s_add_u32 s12, s12, 0x10000
buffer_load_dwordx4 v[148:151], v4, s[44:47], s12 offen nt
s_add_u32 s12, s12, 0x10000
buffer_load_dwordx4 v[152:155], v4, s[44:47], s12 offen nt
s_mul_i32 s12, s3, 112
buffer_load_ushort v160, v7, s[64:67], s12 offen offset:0
buffer_load_ushort v161, v7, s[64:67], s12 offen offset:896
buffer_load_ushort v162, v7, s[64:67], s12 offen offset:16
buffer_load_ushort v163, v7, s[64:67], s12 offen offset:912
buffer_load_ushort v164, v7, s[64:67], s12 offen offset:32
buffer_load_ushort v165, v7, s[64:67], s12 offen offset:928
buffer_load_ushort v166, v7, s[64:67], s12 offen offset:48
buffer_load_ushort v167, v7, s[64:67], s12 offen offset:944
buffer_load_ushort v168, v7, s[64:67], s12 offen offset:64
buffer_load_ushort v169, v7, s[64:67], s12 offen offset:960
buffer_load_ushort v170, v7, s[64:67], s12 offen offset:80
buffer_load_ushort v171, v7, s[64:67], s12 offen offset:976
buffer_load_ushort v172, v7, s[64:67], s12 offen offset:96
buffer_load_ushort v173, v7, s[64:67], s12 offen offset:992
v_mov_b32 v176, 0
v_mov_b32 v177, 0
v_mov_b32 v178, 0
v_mov_b32 v179, 0
v_mov_b32 v180, 0
v_mov_b32 v181, 0
v_mov_b32 v182, 0
v_mov_b32 v183, 0
v_mov_b32 v184, 0
v_mov_b32 v185, 0
v_mov_b32 v186, 0
v_mov_b32 v187, 0
v_mov_b32 v188, 0
v_mov_b32 v189, 0
v_mov_b32 v190, 0
v_mov_b32 v191, 0
s_waitcnt vmcnt(0)
v_lshlrev_b32 v8, 16, v160
v_lshlrev_b32 v9, 16, v161
v_dot2_f32_bf16 v176, v128, v160, v176
v_dot2_f32_bf16 v177, v128, v8, v177
v_dot2_f32_bf16 v178, v129, v160, v178
v_dot2_f32_bf16 v179, v129, v8, v179
v_dot2_f32_bf16 v180, v130, v160, v180
v_dot2_f32_bf16 v181, v130, v8, v181
v_dot2_f32_bf16 v182, v131, v160, v182
v_dot2_f32_bf16 v183, v131, v8, v183
v_dot2_f32_bf16 v184, v128, v161, v184
v_dot2_f32_bf16 v185, v128, v9, v185
v_dot2_f32_bf16 v186, v129, v161, v186
v_dot2_f32_bf16 v187, v129, v9, v187
v_dot2_f32_bf16 v188, v130, v161, v188
v_dot2_f32_bf16 v189, v130, v9, v189
v_dot2_f32_bf16 v190, v131, v161, v190
v_dot2_f32_bf16 v191, v131, v9, v191
v_lshlrev_b32 v8, 16, v162
v_lshlrev_b32 v9, 16, v163
v_dot2_f32_bf16 v176, v132, v162, v176
v_dot2_f32_bf16 v177, v132, v8, v177
v_dot2_f32_bf16 v178, v133, v162, v178
v_dot2_f32_bf16 v179, v133, v8, v179
v_dot2_f32_bf16 v180, v134, v162, v180
v_dot2_f32_bf16 v181, v134, v8, v181
v_dot2_f32_bf16 v182, v135, v162, v182
v_dot2_f32_bf16 v183, v135, v8, v183
v_dot2_f32_bf16 v184, v132, v163, v184
v_dot2_f32_bf16 v185, v132, v9, v185
v_dot2_f32_bf16 v186, v133, v163, v186
v_dot2_f32_bf16 v187, v133, v9, v187
v_dot2_f32_bf16 v188, v134, v163, v188
v_dot2_f32_bf16 v189, v134, v9, v189
v_dot2_f32_bf16 v190, v135, v163, v190
v_dot2_f32_bf16 v191, v135, v9, v191
v_lshlrev_b32 v8, 16, v164
v_lshlrev_b32 v9, 16, v165
v_dot2_f32_bf16 v176, v136, v164, v176
v_dot2_f32_bf16 v177, v136, v8, v177
v_dot2_f32_bf16 v178, v137, v164, v178
v_dot2_f32_bf16 v179, v137, v8, v179
v_dot2_f32_bf16 v180, v138, v164, v180
v_dot2_f32_bf16 v181, v138, v8, v181
v_dot2_f32_bf16 v182, v139, v164, v182
v_dot2_f32_bf16 v183, v139, v8, v183
v_dot2_f32_bf16 v184, v136, v165, v184
v_dot2_f32_bf16 v185, v136, v9, v185
v_dot2_f32_bf16 v186, v137, v165, v186
v_dot2_f32_bf16 v187, v137, v9, v187
v_dot2_f32_bf16 v188, v138, v165, v188
v_dot2_f32_bf16 v189, v138, v9, v189
v_dot2_f32_bf16 v190, v139, v165, v190
v_dot2_f32_bf16 v191, v139, v9, v191
v_lshlrev_b32 v8, 16, v166
v_lshlrev_b32 v9, 16, v167
v_dot2_f32_bf16 v176, v140, v166, v176
v_dot2_f32_bf16 v177, v140, v8, v177
v_dot2_f32_bf16 v178, v141, v166, v178
v_dot2_f32_bf16 v179, v141, v8, v179
v_dot2_f32_bf16 v180, v142, v166, v180
v_dot2_f32_bf16 v181, v142, v8, v181
v_dot2_f32_bf16 v182, v143, v166, v182
v_dot2_f32_bf16 v183, v143, v8, v183
v_dot2_f32_bf16 v184, v140, v167, v184
v_dot2_f32_bf16 v185, v140, v9, v185
v_dot2_f32_bf16 v186, v141, v167, v186
v_dot2_f32_bf16 v187, v141, v9, v187
v_dot2_f32_bf16 v188, v142, v167, v188
v_dot2_f32_bf16 v189, v142, v9, v189
v_dot2_f32_bf16 v190, v143, v167, v190
v_dot2_f32_bf16 v191, v143, v9, v191
v_lshlrev_b32 v8, 16, v168
v_lshlrev_b32 v9, 16, v169
v_dot2_f32_bf16 v176, v144, v168, v176
v_dot2_f32_bf16 v177, v144, v8, v177
v_dot2_f32_bf16 v178, v145, v168, v178
v_dot2_f32_bf16 v179, v145, v8, v179
v_dot2_f32_bf16 v180, v146, v168, v180
v_dot2_f32_bf16 v181, v146, v8, v181
v_dot2_f32_bf16 v182, v147, v168, v182
v_dot2_f32_bf16 v183, v147, v8, v183
v_dot2_f32_bf16 v184, v144, v169, v184
v_dot2_f32_bf16 v185, v144, v9, v185
v_dot2_f32_bf16 v186, v145, v169, v186
v_dot2_f32_bf16 v187, v145, v9, v187
v_dot2_f32_bf16 v188, v146, v169, v188
v_dot2_f32_bf16 v189, v146, v9, v189
v_dot2_f32_bf16 v190, v147, v169, v190
v_dot2_f32_bf16 v191, v147, v9, v191
v_lshlrev_b32 v8, 16, v170
v_lshlrev_b32 v9, 16, v171
v_dot2_f32_bf16 v176, v148, v170, v176
v_dot2_f32_bf16 v177, v148, v8, v177
v_dot2_f32_bf16 v178, v149, v170, v178
v_dot2_f32_bf16 v179, v149, v8, v179
v_dot2_f32_bf16 v180, v150, v170, v180
v_dot2_f32_bf16 v181, v150, v8, v181
v_dot2_f32_bf16 v182, v151, v170, v182
v_dot2_f32_bf16 v183, v151, v8, v183
v_dot2_f32_bf16 v184, v148, v171, v184
v_dot2_f32_bf16 v185, v148, v9, v185
v_dot2_f32_bf16 v186, v149, v171, v186
v_dot2_f32_bf16 v187, v149, v9, v187
v_dot2_f32_bf16 v188, v150, v171, v188
v_dot2_f32_bf16 v189, v150, v9, v189
v_dot2_f32_bf16 v190, v151, v171, v190
v_dot2_f32_bf16 v191, v151, v9, v191
v_lshlrev_b32 v8, 16, v172
v_lshlrev_b32 v9, 16, v173
v_dot2_f32_bf16 v176, v152, v172, v176
v_dot2_f32_bf16 v177, v152, v8, v177
v_dot2_f32_bf16 v178, v153, v172, v178
v_dot2_f32_bf16 v179, v153, v8, v179
v_dot2_f32_bf16 v180, v154, v172, v180
v_dot2_f32_bf16 v181, v154, v8, v181
v_dot2_f32_bf16 v182, v155, v172, v182
v_dot2_f32_bf16 v183, v155, v8, v183
v_dot2_f32_bf16 v184, v152, v173, v184
v_dot2_f32_bf16 v185, v152, v9, v185
v_dot2_f32_bf16 v186, v153, v173, v186
v_dot2_f32_bf16 v187, v153, v9, v187
v_dot2_f32_bf16 v188, v154, v173, v188
v_dot2_f32_bf16 v189, v154, v9, v189
v_dot2_f32_bf16 v190, v155, v173, v190
v_dot2_f32_bf16 v191, v155, v9, v191
s_nop 2
v_add_f32_dpp v176, v176, v176 row_ror:8 row_mask:0xf bank_mask:0xf
v_add_f32_dpp v177, v177, v177 row_ror:8 row_mask:0xf bank_mask:0xf
v_add_f32_dpp v178, v178, v178 row_ror:8 row_mask:0xf bank_mask:0xf
v_add_f32_dpp v179, v179, v179 row_ror:8 row_mask:0xf bank_mask:0xf
v_add_f32_dpp v180, v180, v180 row_ror:8 row_mask:0xf bank_mask:0xf
v_add_f32_dpp v181, v181, v181 row_ror:8 row_mask:0xf bank_mask:0xf
v_add_f32_dpp v182, v182, v182 row_ror:8 row_mask:0xf bank_mask:0xf
v_add_f32_dpp v183, v183, v183 row_ror:8 row_mask:0xf bank_mask:0xf
v_add_f32_dpp v184, v184, v184 row_ror:8 row_mask:0xf bank_mask:0xf
v_add_f32_dpp v185, v185, v185 row_ror:8 row_mask:0xf bank_mask:0xf
v_add_f32_dpp v186, v186, v186 row_ror:8 row_mask:0xf bank_mask:0xf
v_add_f32_dpp v187, v187, v187 row_ror:8 row_mask:0xf bank_mask:0xf
v_add_f32_dpp v188, v188, v188 row_ror:8 row_mask:0xf bank_mask:0xf
v_add_f32_dpp v189, v189, v189 row_ror:8 row_mask:0xf bank_mask:0xf
v_add_f32_dpp v190, v190, v190 row_ror:8 row_mask:0xf bank_mask:0xf
v_add_f32_dpp v191, v191, v191 row_ror:8 row_mask:0xf bank_mask:0xf
v_mov_b32 v192, v176
v_mov_b32 v193, v177
v_mov_b32 v194, v178
v_mov_b32 v195, v179
v_mov_b32 v196, v180
v_mov_b32 v197, v181
v_mov_b32 v198, v182
v_mov_b32 v199, v183
v_mov_b32 v200, v184
v_mov_b32 v201, v185
v_mov_b32 v202, v186
v_mov_b32 v203, v187
v_mov_b32 v204, v188
v_mov_b32 v205, v189
v_mov_b32 v206, v190
v_mov_b32 v207, v191
s_nop 1
v_permlane16_swap_b32 v176, v192
v_permlane16_swap_b32 v177, v193
v_permlane16_swap_b32 v178, v194
v_permlane16_swap_b32 v179, v195
v_permlane16_swap_b32 v180, v196
v_permlane16_swap_b32 v181, v197
v_permlane16_swap_b32 v182, v198
v_permlane16_swap_b32 v183, v199
v_permlane16_swap_b32 v184, v200
v_permlane16_swap_b32 v185, v201
v_permlane16_swap_b32 v186, v202
v_permlane16_swap_b32 v187, v203
v_permlane16_swap_b32 v188, v204
v_permlane16_swap_b32 v189, v205
v_permlane16_swap_b32 v190, v206
v_permlane16_swap_b32 v191, v207
s_nop 1
v_add_f32 v176, v176, v192
v_add_f32 v177, v177, v193
v_add_f32 v178, v178, v194
v_add_f32 v179, v179, v195
v_add_f32 v180, v180, v196
v_add_f32 v181, v181, v197
v_add_f32 v182, v182, v198
v_add_f32 v183, v183, v199
v_add_f32 v184, v184, v200
v_add_f32 v185, v185, v201
v_add_f32 v186, v186, v202
v_add_f32 v187, v187, v203
v_add_f32 v188, v188, v204
v_add_f32 v189, v189, v205
v_add_f32 v190, v190, v206
v_add_f32 v191, v191, v207
v_mov_b32 v192, v176
v_mov_b32 v193, v177
v_mov_b32 v194, v178
v_mov_b32 v195, v179
v_mov_b32 v196, v180
v_mov_b32 v197, v181
v_mov_b32 v198, v182
v_mov_b32 v199, v183
v_mov_b32 v200, v184
v_mov_b32 v201, v185
v_mov_b32 v202, v186
v_mov_b32 v203, v187
v_mov_b32 v204, v188
v_mov_b32 v205, v189
v_mov_b32 v206, v190
v_mov_b32 v207, v191
s_nop 1
v_permlane32_swap_b32 v176, v192
v_permlane32_swap_b32 v177, v193
v_permlane32_swap_b32 v178, v194
v_permlane32_swap_b32 v179, v195
v_permlane32_swap_b32 v180, v196
v_permlane32_swap_b32 v181, v197
v_permlane32_swap_b32 v182, v198
v_permlane32_swap_b32 v183, v199
v_permlane32_swap_b32 v184, v200
v_permlane32_swap_b32 v185, v201
v_permlane32_swap_b32 v186, v202
v_permlane32_swap_b32 v187, v203
v_permlane32_swap_b32 v188, v204
v_permlane32_swap_b32 v189, v205
v_permlane32_swap_b32 v190, v206
v_permlane32_swap_b32 v191, v207
s_nop 1
v_add_f32 v176, v176, v192
v_add_f32 v177, v177, v193
v_add_f32 v178, v178, v194
v_add_f32 v179, v179, v195
v_add_f32 v180, v180, v196
v_add_f32 v181, v181, v197
v_add_f32 v182, v182, v198
v_add_f32 v183, v183, v199
v_add_f32 v184, v184, v200
v_add_f32 v185, v185, v201
v_add_f32 v186, v186, v202
v_add_f32 v187, v187, v203
v_add_f32 v188, v188, v204
v_add_f32 v189, v189, v205
v_add_f32 v190, v190, v206
v_add_f32 v191, v191, v207
s_lshl_b32 s12, s3, 9
v_lshlrev_b32 v8, 5, v11
v_add_u32 v8, s12, v8
s_mov_b64 exec, 0xff
ds_write_b128 v8, v[176:179] offset:0
ds_write_b128 v8, v[180:183] offset:16
ds_write_b128 v8, v[184:187] offset:256
ds_write_b128 v8, v[188:191] offset:272
s_mov_b64 exec, -1
s_waitcnt lgkmcnt(0)
s_barrier
s_cmp_lg_u32 s3, 0
s_cbranch_scc1 L_S0_done
v_lshlrev_b32 v8, 2, v1
ds_read_b32 v128, v8 offset:0
ds_read_b32 v136, v8 offset:256
ds_read_b32 v129, v8 offset:512
ds_read_b32 v137, v8 offset:768
ds_read_b32 v130, v8 offset:1024
ds_read_b32 v138, v8 offset:1280
ds_read_b32 v131, v8 offset:1536
ds_read_b32 v139, v8 offset:1792
ds_read_b32 v132, v8 offset:2048
ds_read_b32 v140, v8 offset:2304
ds_read_b32 v133, v8 offset:2560
ds_read_b32 v141, v8 offset:2816
ds_read_b32 v134, v8 offset:3072
ds_read_b32 v142, v8 offset:3328
ds_read_b32 v135, v8 offset:3584
ds_read_b32 v143, v8 offset:3840
s_waitcnt lgkmcnt(0)
v_add_f32 v128, v128, v132
v_add_f32 v129, v129, v133
v_add_f32 v130, v130, v134
v_add_f32 v131, v131, v135
v_add_f32 v136, v136, v140
v_add_f32 v137, v137, v141
v_add_f32 v138, v138, v142
v_add_f32 v139, v139, v143
v_add_f32 v128, v128, v130
v_add_f32 v129, v129, v131
v_add_f32 v136, v136, v138
v_add_f32 v137, v137, v139
v_add_f32 v128, v128, v129
v_add_f32 v136, v136, v137
v_cvt_pk_bf16_f32 v128, v128, v136
v_lshlrev_b32 v8, 1, v1
ds_write_b16 v8, v128 offset:4096
ds_write_b16_d16_hi v8, v128 offset:4224
v_lshlrev_b32 v8, 4, v1
s_waitcnt lgkmcnt(0)
s_mov_b64 exec, 0xffff
ds_read_b128 v[128:131], v8 offset:4096
s_lshl_b32 s10, s92, 14
s_add_u32 s10, s10, s93
s_add_u32 s10, s10, 720896
s_waitcnt lgkmcnt(0)
buffer_store_dwordx4 v[128:131], v4, s[56:59], s10 offen sc1
s_and_b32 s10, s13, 0x43
s_cmp_lg_u32 s10, 0
s_cbranch_scc1 L_S0_nz
s_lshl_b32 s10, s13, 5
s_add_u32 s10, s10, 1015808
v_lshlrev_b32 v8, 11, v1
v_mov_b32 v9, 0
s_mov_b64 exec, 3
buffer_store_dword v9, v8, s[56:59], s10 offen sc1
L_S0_nz:
s_mov_b64 exec, -1
v_mov_b32 v9, 0
s_mov_b32 s11, 0
L_nl_s0:
buffer_load_dwordx2 v[10:11], v9, s[60:63], 0 offen sc1
s_waitcnt vmcnt(0)
v_readfirstlane_b32 s94, v10
v_readfirstlane_b32 s95, v11
s_cmp_lg_u64 s[94:95], 0
s_cbranch_scc1 L_nd_s0
s_sleep 4
s_add_u32 s11, s11, 1
s_cmp_lt_u32 s11, 0x40000
s_cbranch_scc1 L_nl_s0
L_nd_s0:
v_mov_b32 v10, s94
v_mov_b32 v11, s95
s_lshl_b32 s10, s13, 7
s_add_u32 s10, s10, 0xe0000
v_mov_b32 v9, 0
s_mov_b64 exec, 1
buffer_store_dwordx2 v[10:11], v9, s[56:59], s10 offen sc1
s_mov_b64 exec, -1
L_S0_done:
L_A_head:
s_cmp_lg_u32 s3, 0
s_cbranch_scc1 L_A_pf
v_lshlrev_b32 v9, 7, v1
s_mov_b32 s10, 0xe0000
s_lshl_b32 s11, s4, 9
s_add_u32 s10, s10, s11
s_mov_b32 s11, 0
s_mov_b64 exec, 0xf
L_pl_qa:
buffer_load_dwordx2 v[10:11], v9, s[56:59], s10 offen sc1
s_waitcnt vmcnt(0)
v_cmp_ne_u64 vcc, s[94:95], v[10:11]
s_cmp_eq_u64 vcc, 0
s_cbranch_scc1 L_pd_qa
s_sleep 16
s_add_u32 s11, s11, 1
s_cmp_lt_u32 s11, 0x40000
s_cbranch_scc1 L_pl_qa
L_pd_qa:
s_mov_b64 exec, -1
v_lshlrev_b32 v8, 4, v1
s_lshl_b32 s10, s5, 13
s_lshl_b32 s11, s4, 9
s_add_u32 s10, s10, s11
s_add_u32 s10, s10, 720896
s_mov_b64 exec, 0xffffffff
buffer_load_dwordx4 v[16:19], v8, s[56:59], s10 offen sc1
s_waitcnt vmcnt(0)
ds_write_b128 v8, v[16:19] offset:16384
v_mov_b32 v8, s94
v_mov_b32 v9, 0
ds_write_b32 v9, v8 offset:16896
s_mov_b64 exec, -1
s_waitcnt lgkmcnt(0)
s_barrier
L_A_pf:
s_cmp_lt_u32 s6, 4
s_cbranch_scc1 L_A_pf2
L_A_pf2:
s_add_u32 s10, s7, 0
buffer_load_dwordx4 v[32:35], v5, s[48:51], s10 offen offset:0 nt
buffer_load_dwordx4 v[36:39], v5, s[48:51], s10 offen offset:128 nt
buffer_load_dwordx4 v[40:43], v5, s[48:51], s10 offen offset:256 nt
buffer_load_dwordx4 v[44:47], v5, s[48:51], s10 offen offset:384 nt
s_add_u32 s10, s7, 4096
buffer_load_dwordx4 v[48:51], v5, s[48:51], s10 offen offset:0 nt
buffer_load_dwordx4 v[52:55], v5, s[48:51], s10 offen offset:128 nt
buffer_load_dwordx4 v[56:59], v5, s[48:51], s10 offen offset:256 nt
buffer_load_dwordx4 v[60:63], v5, s[48:51], s10 offen offset:384 nt
s_add_u32 s10, s7, 8192
buffer_load_dwordx4 v[64:67], v5, s[48:51], s10 offen offset:0 nt
buffer_load_dwordx4 v[68:71], v5, s[48:51], s10 offen offset:128 nt
buffer_load_dwordx4 v[72:75], v5, s[48:51], s10 offen offset:256 nt
buffer_load_dwordx4 v[76:79], v5, s[48:51], s10 offen offset:384 nt
s_add_u32 s10, s7, 12288
buffer_load_dwordx4 v[80:83], v5, s[48:51], s10 offen offset:0 nt
buffer_load_dwordx4 v[84:87], v5, s[48:51], s10 offen offset:128 nt
buffer_load_dwordx4 v[88:91], v5, s[48:51], s10 offen offset:256 nt
buffer_load_dwordx4 v[92:95], v5, s[48:51], s10 offen offset:384 nt
s_waitcnt vmcnt(12)
s_add_u32 s10, s7, 16384
buffer_load_dwordx4 v[96:99], v5, s[48:51], s10 offen offset:0 nt
buffer_load_dwordx4 v[100:103], v5, s[48:51], s10 offen offset:128 nt
buffer_load_dwordx4 v[104:107], v5, s[48:51], s10 offen offset:256 nt
buffer_load_dwordx4 v[108:111], v5, s[48:51], s10 offen offset:384 nt
s_waitcnt vmcnt(12)
s_add_u32 s10, s7, 20480
buffer_load_dwordx4 v[112:115], v5, s[48:51], s10 offen offset:0 nt
buffer_load_dwordx4 v[116:119], v5, s[48:51], s10 offen offset:128 nt
buffer_load_dwordx4 v[120:123], v5, s[48:51], s10 offen offset:256 nt
buffer_load_dwordx4 v[124:127], v5, s[48:51], s10 offen offset:384 nt
s_cmp_eq_u32 s3, 0
s_cbranch_scc1 L_A_nb
s_barrier
L_A_nb:
v_and_b32 v8, 1, v2
v_lshlrev_b32 v8, 6, v8
v_lshl_add_u32 v8, v3, 4, v8
ds_read_b128 v[16:19], v8 offset:16384
ds_read_b128 v[20:23], v8 offset:16512
ds_read_b128 v[24:27], v8 offset:16640
ds_read_b128 v[28:31], v8 offset:16768
s_waitcnt lgkmcnt(0)
s_cmp_eq_u32 s14, 3
s_cbranch_scc1 L_A3
s_waitcnt vmcnt(12)
v_mfma_f32_16x16x32_bf16 v[228:231], v[32:35], v[16:19], 0
v_mfma_f32_16x16x32_bf16 v[228:231], v[36:39], v[20:23], v[228:231]
v_mfma_f32_16x16x32_bf16 v[228:231], v[40:43], v[24:27], v[228:231]
v_mfma_f32_16x16x32_bf16 v[228:231], v[44:47], v[28:31], v[228:231]
s_add_u32 s10, s7, 24576
buffer_load_dwordx4 v[32:35], v5, s[48:51], s10 offen offset:0 nt
buffer_load_dwordx4 v[36:39], v5, s[48:51], s10 offen offset:128 nt
buffer_load_dwordx4 v[40:43], v5, s[48:51], s10 offen offset:256 nt
buffer_load_dwordx4 v[44:47], v5, s[48:51], s10 offen offset:384 nt
s_waitcnt vmcnt(12)
v_mfma_f32_16x16x32_bf16 v[232:235], v[48:51], v[16:19], 0
v_mfma_f32_16x16x32_bf16 v[232:235], v[52:55], v[20:23], v[232:235]
v_mfma_f32_16x16x32_bf16 v[232:235], v[56:59], v[24:27], v[232:235]
v_mfma_f32_16x16x32_bf16 v[232:235], v[60:63], v[28:31], v[232:235]
s_add_u32 s10, s7, 28672
buffer_load_dwordx4 v[48:51], v5, s[48:51], s10 offen offset:0 nt
buffer_load_dwordx4 v[52:55], v5, s[48:51], s10 offen offset:128 nt
buffer_load_dwordx4 v[56:59], v5, s[48:51], s10 offen offset:256 nt
buffer_load_dwordx4 v[60:63], v5, s[48:51], s10 offen offset:384 nt
s_nop 7
s_nop 1
v_permlane32_swap_b32 v228, v232
v_permlane32_swap_b32 v229, v233
v_permlane32_swap_b32 v230, v234
v_permlane32_swap_b32 v231, v235
s_nop 0
v_add_f32_dpp v192, v232, v228 quad_perm:[1,0,3,2] row_mask:0xf bank_mask:0xf
v_add_f32_dpp v193, v233, v229 quad_perm:[1,0,3,2] row_mask:0xf bank_mask:0xf
v_add_f32_dpp v194, v234, v230 quad_perm:[1,0,3,2] row_mask:0xf bank_mask:0xf
v_add_f32_dpp v195, v235, v231 quad_perm:[1,0,3,2] row_mask:0xf bank_mask:0xf
v_cvt_pk_bf16_f32 v8, v192, v193
v_cvt_pk_bf16_f32 v9, v194, v195
v_lshlrev_b32 v192, 16, v8
v_and_b32 v193, 0xffff0000, v8
v_lshlrev_b32 v194, 16, v9
v_and_b32 v195, 0xffff0000, v9
s_waitcnt vmcnt(12)
v_mfma_f32_16x16x32_bf16 v[228:231], v[64:67], v[16:19], 0
v_mfma_f32_16x16x32_bf16 v[228:231], v[68:71], v[20:23], v[228:231]
v_mfma_f32_16x16x32_bf16 v[228:231], v[72:75], v[24:27], v[228:231]
v_mfma_f32_16x16x32_bf16 v[228:231], v[76:79], v[28:31], v[228:231]
s_add_u32 s10, s7, 32768
buffer_load_dwordx4 v[64:67], v5, s[48:51], s10 offen offset:0 nt
buffer_load_dwordx4 v[68:71], v5, s[48:51], s10 offen offset:128 nt
buffer_load_dwordx4 v[72:75], v5, s[48:51], s10 offen offset:256 nt
buffer_load_dwordx4 v[76:79], v5, s[48:51], s10 offen offset:384 nt
s_waitcnt vmcnt(12)
v_mfma_f32_16x16x32_bf16 v[232:235], v[80:83], v[16:19], 0
v_mfma_f32_16x16x32_bf16 v[232:235], v[84:87], v[20:23], v[232:235]
v_mfma_f32_16x16x32_bf16 v[232:235], v[88:91], v[24:27], v[232:235]
v_mfma_f32_16x16x32_bf16 v[232:235], v[92:95], v[28:31], v[232:235]
s_add_u32 s10, s7, 36864
buffer_load_dwordx4 v[80:83], v5, s[48:51], s10 offen offset:0 nt
buffer_load_dwordx4 v[84:87], v5, s[48:51], s10 offen offset:128 nt
buffer_load_dwordx4 v[88:91], v5, s[48:51], s10 offen offset:256 nt
buffer_load_dwordx4 v[92:95], v5, s[48:51], s10 offen offset:384 nt
s_nop 7
s_nop 1
v_permlane32_swap_b32 v228, v232
v_permlane32_swap_b32 v229, v233
v_permlane32_swap_b32 v230, v234
v_permlane32_swap_b32 v231, v235
s_nop 0
v_add_f32_dpp v196, v232, v228 quad_perm:[1,0,3,2] row_mask:0xf bank_mask:0xf
v_add_f32_dpp v197, v233, v229 quad_perm:[1,0,3,2] row_mask:0xf bank_mask:0xf
v_add_f32_dpp v198, v234, v230 quad_perm:[1,0,3,2] row_mask:0xf bank_mask:0xf
v_add_f32_dpp v199, v235, v231 quad_perm:[1,0,3,2] row_mask:0xf bank_mask:0xf
v_cvt_pk_bf16_f32 v8, v196, v197
v_cvt_pk_bf16_f32 v9, v198, v199
v_lshlrev_b32 v196, 16, v8
v_and_b32 v197, 0xffff0000, v8
v_lshlrev_b32 v198, 16, v9
v_and_b32 v199, 0xffff0000, v9
s_waitcnt vmcnt(12)
v_mfma_f32_16x16x32_bf16 v[228:231], v[96:99], v[16:19], 0
v_mfma_f32_16x16x32_bf16 v[228:231], v[100:103], v[20:23], v[228:231]
v_mfma_f32_16x16x32_bf16 v[228:231], v[104:107], v[24:27], v[228:231]
v_mfma_f32_16x16x32_bf16 v[228:231], v[108:111], v[28:31], v[228:231]
s_add_u32 s10, s7, 0
buffer_load_dwordx4 v[96:99], v6, s[52:55], s10 offen offset:0 nt
buffer_load_dwordx4 v[100:103], v6, s[52:55], s10 offen offset:512 nt
buffer_load_dwordx4 v[104:107], v6, s[52:55], s10 offen offset:1024 nt
buffer_load_dwordx4 v[108:111], v6, s[52:55], s10 offen offset:1536 nt
s_waitcnt vmcnt(12)
v_mfma_f32_16x16x32_bf16 v[232:235], v[112:115], v[16:19], 0
v_mfma_f32_16x16x32_bf16 v[232:235], v[116:119], v[20:23], v[232:235]
v_mfma_f32_16x16x32_bf16 v[232:235], v[120:123], v[24:27], v[232:235]
v_mfma_f32_16x16x32_bf16 v[232:235], v[124:127], v[28:31], v[232:235]
s_add_u32 s10, s7, 0
buffer_load_dwordx4 v[112:115], v6, s[52:55], s10 offen offset:256 nt
buffer_load_dwordx4 v[116:119], v6, s[52:55], s10 offen offset:768 nt
buffer_load_dwordx4 v[120:123], v6, s[52:55], s10 offen offset:1280 nt
buffer_load_dwordx4 v[124:127], v6, s[52:55], s10 offen offset:1792 nt
s_nop 7
s_nop 1
v_permlane32_swap_b32 v228, v232
v_permlane32_swap_b32 v229, v233
v_permlane32_swap_b32 v230, v234
v_permlane32_swap_b32 v231, v235
s_nop 0
v_add_f32_dpp v200, v232, v228 quad_perm:[1,0,3,2] row_mask:0xf bank_mask:0xf
v_add_f32_dpp v201, v233, v229 quad_perm:[1,0,3,2] row_mask:0xf bank_mask:0xf
v_add_f32_dpp v202, v234, v230 quad_perm:[1,0,3,2] row_mask:0xf bank_mask:0xf
v_add_f32_dpp v203, v235, v231 quad_perm:[1,0,3,2] row_mask:0xf bank_mask:0xf
v_cvt_pk_bf16_f32 v8, v200, v201
v_cvt_pk_bf16_f32 v9, v202, v203
v_lshlrev_b32 v200, 16, v8
v_and_b32 v201, 0xffff0000, v8
v_lshlrev_b32 v202, 16, v9
v_and_b32 v203, 0xffff0000, v9
s_waitcnt vmcnt(12)
v_mfma_f32_16x16x32_bf16 v[228:231], v[32:35], v[16:19], 0
v_mfma_f32_16x16x32_bf16 v[228:231], v[36:39], v[20:23], v[228:231]
v_mfma_f32_16x16x32_bf16 v[228:231], v[40:43], v[24:27], v[228:231]
v_mfma_f32_16x16x32_bf16 v[228:231], v[44:47], v[28:31], v[228:231]
s_add_u32 s10, s7, 8192
buffer_load_dwordx4 v[32:35], v6, s[52:55], s10 offen offset:0 nt
buffer_load_dwordx4 v[36:39], v6, s[52:55], s10 offen offset:512 nt
buffer_load_dwordx4 v[40:43], v6, s[52:55], s10 offen offset:1024 nt
buffer_load_dwordx4 v[44:47], v6, s[52:55], s10 offen offset:1536 nt
s_waitcnt vmcnt(12)
v_mfma_f32_16x16x32_bf16 v[232:235], v[48:51], v[16:19], 0
v_mfma_f32_16x16x32_bf16 v[232:235], v[52:55], v[20:23], v[232:235]
v_mfma_f32_16x16x32_bf16 v[232:235], v[56:59], v[24:27], v[232:235]
v_mfma_f32_16x16x32_bf16 v[232:235], v[60:63], v[28:31], v[232:235]
s_add_u32 s10, s7, 8192
buffer_load_dwordx4 v[48:51], v6, s[52:55], s10 offen offset:256 nt
buffer_load_dwordx4 v[52:55], v6, s[52:55], s10 offen offset:768 nt
buffer_load_dwordx4 v[56:59], v6, s[52:55], s10 offen offset:1280 nt
buffer_load_dwordx4 v[60:63], v6, s[52:55], s10 offen offset:1792 nt
s_nop 7
s_nop 1
v_permlane32_swap_b32 v228, v232
v_permlane32_swap_b32 v229, v233
v_permlane32_swap_b32 v230, v234
v_permlane32_swap_b32 v231, v235
s_nop 0
v_add_f32_dpp v204, v232, v228 quad_perm:[1,0,3,2] row_mask:0xf bank_mask:0xf
v_add_f32_dpp v205, v233, v229 quad_perm:[1,0,3,2] row_mask:0xf bank_mask:0xf
v_add_f32_dpp v206, v234, v230 quad_perm:[1,0,3,2] row_mask:0xf bank_mask:0xf
v_add_f32_dpp v207, v235, v231 quad_perm:[1,0,3,2] row_mask:0xf bank_mask:0xf
v_cvt_pk_bf16_f32 v8, v204, v205
v_cvt_pk_bf16_f32 v9, v206, v207
v_lshlrev_b32 v204, 16, v8
v_and_b32 v205, 0xffff0000, v8
v_lshlrev_b32 v206, 16, v9
v_and_b32 v207, 0xffff0000, v9
s_waitcnt vmcnt(12)
v_mfma_f32_16x16x32_bf16 v[228:231], v[64:67], v[16:19], 0
v_mfma_f32_16x16x32_bf16 v[228:231], v[68:71], v[20:23], v[228:231]
v_mfma_f32_16x16x32_bf16 v[228:231], v[72:75], v[24:27], v[228:231]
v_mfma_f32_16x16x32_bf16 v[228:231], v[76:79], v[28:31], v[228:231]
s_add_u32 s10, s7, 16384
buffer_load_dwordx4 v[64:67], v6, s[52:55], s10 offen offset:0 nt
buffer_load_dwordx4 v[68:71], v6, s[52:55], s10 offen offset:512 nt
buffer_load_dwordx4 v[72:75], v6, s[52:55], s10 offen offset:1024 nt
buffer_load_dwordx4 v[76:79], v6, s[52:55], s10 offen offset:1536 nt
s_waitcnt vmcnt(12)
v_mfma_f32_16x16x32_bf16 v[232:235], v[80:83], v[16:19], 0
v_mfma_f32_16x16x32_bf16 v[232:235], v[84:87], v[20:23], v[232:235]
v_mfma_f32_16x16x32_bf16 v[232:235], v[88:91], v[24:27], v[232:235]
v_mfma_f32_16x16x32_bf16 v[232:235], v[92:95], v[28:31], v[232:235]
s_add_u32 s10, s7, 16384
buffer_load_dwordx4 v[80:83], v6, s[52:55], s10 offen offset:256 nt
buffer_load_dwordx4 v[84:87], v6, s[52:55], s10 offen offset:768 nt
buffer_load_dwordx4 v[88:91], v6, s[52:55], s10 offen offset:1280 nt
buffer_load_dwordx4 v[92:95], v6, s[52:55], s10 offen offset:1792 nt
s_nop 7
s_nop 1
v_permlane32_swap_b32 v228, v232
v_permlane32_swap_b32 v229, v233
v_permlane32_swap_b32 v230, v234
v_permlane32_swap_b32 v231, v235
s_nop 0
v_add_f32_dpp v208, v232, v228 quad_perm:[1,0,3,2] row_mask:0xf bank_mask:0xf
v_add_f32_dpp v209, v233, v229 quad_perm:[1,0,3,2] row_mask:0xf bank_mask:0xf
v_add_f32_dpp v210, v234, v230 quad_perm:[1,0,3,2] row_mask:0xf bank_mask:0xf
v_add_f32_dpp v211, v235, v231 quad_perm:[1,0,3,2] row_mask:0xf bank_mask:0xf
v_cvt_pk_bf16_f32 v8, v208, v209
v_cvt_pk_bf16_f32 v9, v210, v211
v_lshlrev_b32 v208, 16, v8
v_and_b32 v209, 0xffff0000, v8
v_lshlrev_b32 v210, 16, v9
v_and_b32 v211, 0xffff0000, v9
v_max_f32 v12, v192, v193
v_max3_f32 v12, v12, v194, v195
v_max3_f32 v12, v12, v196, v197
v_max3_f32 v12, v12, v198, v199
v_max3_f32 v12, v12, v200, v201
v_max3_f32 v12, v12, v202, v203
v_max3_f32 v12, v12, v204, v205
v_max3_f32 v12, v12, v206, v207
v_max3_f32 v12, v12, v208, v209
v_max3_f32 v12, v12, v210, v211
v_mov_b32 v8, v12
s_nop 1
v_permlane32_swap_b32 v12, v8
s_nop 1
v_max_f32 v12, v12, v8
v_mov_b32 v8, v12
s_nop 1
v_permlane16_swap_b32 v12, v8
s_nop 1
v_max_f32 v12, v12, v8
v_mul_f32 v9, s15, v12
v_fma_f32 v192, v192, s15, -v9
v_fma_f32 v193, v193, s15, -v9
v_fma_f32 v194, v194, s15, -v9
v_fma_f32 v195, v195, s15, -v9
v_fma_f32 v196, v196, s15, -v9
v_fma_f32 v197, v197, s15, -v9
v_fma_f32 v198, v198, s15, -v9
v_fma_f32 v199, v199, s15, -v9
v_fma_f32 v200, v200, s15, -v9
v_fma_f32 v201, v201, s15, -v9
v_fma_f32 v202, v202, s15, -v9
v_fma_f32 v203, v203, s15, -v9
v_fma_f32 v204, v204, s15, -v9
v_fma_f32 v205, v205, s15, -v9
v_fma_f32 v206, v206, s15, -v9
v_fma_f32 v207, v207, s15, -v9
v_fma_f32 v208, v208, s15, -v9
v_fma_f32 v209, v209, s15, -v9
v_fma_f32 v210, v210, s15, -v9
v_fma_f32 v211, v211, s15, -v9
v_exp_f32 v192, v192
v_exp_f32 v193, v193
v_exp_f32 v194, v194
v_exp_f32 v195, v195
v_exp_f32 v196, v196
v_exp_f32 v197, v197
v_exp_f32 v198, v198
v_exp_f32 v199, v199
v_exp_f32 v200, v200
v_exp_f32 v201, v201
v_exp_f32 v202, v202
v_exp_f32 v203, v203
v_exp_f32 v204, v204
v_exp_f32 v205, v205
v_exp_f32 v206, v206
v_exp_f32 v207, v207
v_exp_f32 v208, v208
v_exp_f32 v209, v209
v_exp_f32 v210, v210
v_exp_f32 v211, v211
s_nop 0
v_add_f32 v13, v192, v193
v_add_f32 v13, v13, v194
v_add_f32 v13, v13, v195
v_add_f32 v13, v13, v196
v_add_f32 v13, v13, v197
v_add_f32 v13, v13, v198
v_add_f32 v13, v13, v199
v_add_f32 v13, v13, v200
v_add_f32 v13, v13, v201
v_add_f32 v13, v13, v202
v_add_f32 v13, v13, v203
v_add_f32 v13, v13, v204
v_add_f32 v13, v13, v205
v_add_f32 v13, v13, v206
v_add_f32 v13, v13, v207
v_add_f32 v13, v13, v208
v_add_f32 v13, v13, v209
v_add_f32 v13, v13, v210
v_add_f32 v13, v13, v211
v_cvt_pk_bf16_f32 v216, v192, v193
v_cvt_pk_bf16_f32 v217, v194, v195
v_cvt_pk_bf16_f32 v218, v196, v197
v_cvt_pk_bf16_f32 v219, v198, v199
v_cvt_pk_bf16_f32 v220, v200, v201
v_cvt_pk_bf16_f32 v221, v202, v203
v_cvt_pk_bf16_f32 v222, v204, v205
v_cvt_pk_bf16_f32 v223, v206, v207
v_cvt_pk_bf16_f32 v224, v208, v209
v_cvt_pk_bf16_f32 v225, v210, v211
v_mov_b32 v8, v13
s_nop 1
v_permlane32_swap_b32 v13, v8
s_nop 1
v_add_f32 v13, v13, v8
v_mov_b32 v8, v13
s_nop 1
v_permlane16_swap_b32 v13, v8
s_nop 1
v_add_f32 v13, v13, v8
s_waitcnt vmcnt(12)
v_perm_b32 v236, v100, v96, s100
v_perm_b32 v237, v108, v104, s100
v_perm_b32 v238, v100, v96, s101
v_perm_b32 v239, v108, v104, s101
v_perm_b32 v240, v101, v97, s100
v_perm_b32 v241, v109, v105, s100
v_perm_b32 v242, v101, v97, s101
v_perm_b32 v243, v109, v105, s101
v_mfma_f32_16x16x16_bf16 v[128:131], v[216:217], v[236:237], 0
v_mfma_f32_16x16x16_bf16 v[132:135], v[216:217], v[238:239], 0
v_perm_b32 v244, v102, v98, s100
v_perm_b32 v245, v110, v106, s100
v_perm_b32 v246, v102, v98, s101
v_perm_b32 v247, v110, v106, s101
v_mfma_f32_16x16x16_bf16 v[136:139], v[216:217], v[240:241], 0
v_mfma_f32_16x16x16_bf16 v[140:143], v[216:217], v[242:243], 0
v_perm_b32 v248, v103, v99, s100
v_perm_b32 v249, v111, v107, s100
v_perm_b32 v250, v103, v99, s101
v_perm_b32 v251, v111, v107, s101
v_mfma_f32_16x16x16_bf16 v[144:147], v[216:217], v[244:245], 0
v_mfma_f32_16x16x16_bf16 v[148:151], v[216:217], v[246:247], 0
s_nop 1
v_mfma_f32_16x16x16_bf16 v[152:155], v[216:217], v[248:249], 0
v_mfma_f32_16x16x16_bf16 v[156:159], v[216:217], v[250:251], 0
s_add_u32 s10, s7, 24576
buffer_load_dwordx4 v[96:99], v6, s[52:55], s10 offen offset:0 nt
buffer_load_dwordx4 v[100:103], v6, s[52:55], s10 offen offset:512 nt
buffer_load_dwordx4 v[104:107], v6, s[52:55], s10 offen offset:1024 nt
buffer_load_dwordx4 v[108:111], v6, s[52:55], s10 offen offset:1536 nt
s_waitcnt vmcnt(12)
v_perm_b32 v236, v116, v112, s100
v_perm_b32 v237, v124, v120, s100
v_perm_b32 v238, v116, v112, s101
v_perm_b32 v239, v124, v120, s101
v_perm_b32 v240, v117, v113, s100
v_perm_b32 v241, v125, v121, s100
v_perm_b32 v242, v117, v113, s101
v_perm_b32 v243, v125, v121, s101
v_mfma_f32_16x16x16_bf16 v[160:163], v[216:217], v[236:237], 0
v_mfma_f32_16x16x16_bf16 v[164:167], v[216:217], v[238:239], 0
v_perm_b32 v244, v118, v114, s100
v_perm_b32 v245, v126, v122, s100
v_perm_b32 v246, v118, v114, s101
v_perm_b32 v247, v126, v122, s101
v_mfma_f32_16x16x16_bf16 v[168:171], v[216:217], v[240:241], 0
v_mfma_f32_16x16x16_bf16 v[172:175], v[216:217], v[242:243], 0
v_perm_b32 v248, v119, v115, s100
v_perm_b32 v249, v127, v123, s100
v_perm_b32 v250, v119, v115, s101
v_perm_b32 v251, v127, v123, s101
v_mfma_f32_16x16x16_bf16 v[176:179], v[216:217], v[244:245], 0
v_mfma_f32_16x16x16_bf16 v[180:183], v[216:217], v[246:247], 0
s_nop 1
v_mfma_f32_16x16x16_bf16 v[184:187], v[216:217], v[248:249], 0
v_mfma_f32_16x16x16_bf16 v[188:191], v[216:217], v[250:251], 0
s_add_u32 s10, s7, 24576
buffer_load_dwordx4 v[112:115], v6, s[52:55], s10 offen offset:256 nt
buffer_load_dwordx4 v[116:119], v6, s[52:55], s10 offen offset:768 nt
buffer_load_dwordx4 v[120:123], v6, s[52:55], s10 offen offset:1280 nt
buffer_load_dwordx4 v[124:127], v6, s[52:55], s10 offen offset:1792 nt
s_waitcnt vmcnt(12)
v_perm_b32 v236, v36, v32, s100
v_perm_b32 v237, v44, v40, s100
v_perm_b32 v238, v36, v32, s101
v_perm_b32 v239, v44, v40, s101
v_perm_b32 v240, v37, v33, s100
v_perm_b32 v241, v45, v41, s100
v_perm_b32 v242, v37, v33, s101
v_perm_b32 v243, v45, v41, s101
v_mfma_f32_16x16x16_bf16 v[128:131], v[218:219], v[236:237], v[128:131]
v_mfma_f32_16x16x16_bf16 v[132:135], v[218:219], v[238:239], v[132:135]
v_perm_b32 v244, v38, v34, s100
v_perm_b32 v245, v46, v42, s100
v_perm_b32 v246, v38, v34, s101
v_perm_b32 v247, v46, v42, s101
v_mfma_f32_16x16x16_bf16 v[136:139], v[218:219], v[240:241], v[136:139]
v_mfma_f32_16x16x16_bf16 v[140:143], v[218:219], v[242:243], v[140:143]
v_perm_b32 v248, v39, v35, s100
v_perm_b32 v249, v47, v43, s100
v_perm_b32 v250, v39, v35, s101
v_perm_b32 v251, v47, v43, s101
v_mfma_f32_16x16x16_bf16 v[144:147], v[218:219], v[244:245], v[144:147]
v_mfma_f32_16x16x16_bf16 v[148:151], v[218:219], v[246:247], v[148:151]
s_nop 1
v_mfma_f32_16x16x16_bf16 v[152:155], v[218:219], v[248:249], v[152:155]
v_mfma_f32_16x16x16_bf16 v[156:159], v[218:219], v[250:251], v[156:159]
s_add_u32 s10, s7, 32768
buffer_load_dwordx4 v[32:35], v6, s[52:55], s10 offen offset:0 nt
buffer_load_dwordx4 v[36:39], v6, s[52:55], s10 offen offset:512 nt
buffer_load_dwordx4 v[40:43], v6, s[52:55], s10 offen offset:1024 nt
buffer_load_dwordx4 v[44:47], v6, s[52:55], s10 offen offset:1536 nt
s_waitcnt vmcnt(12)
v_perm_b32 v236, v52, v48, s100
v_perm_b32 v237, v60, v56, s100
v_perm_b32 v238, v52, v48, s101
v_perm_b32 v239, v60, v56, s101
v_perm_b32 v240, v53, v49, s100
v_perm_b32 v241, v61, v57, s100
v_perm_b32 v242, v53, v49, s101
v_perm_b32 v243, v61, v57, s101
v_mfma_f32_16x16x16_bf16 v[160:163], v[218:219], v[236:237], v[160:163]
v_mfma_f32_16x16x16_bf16 v[164:167], v[218:219], v[238:239], v[164:167]
v_perm_b32 v244, v54, v50, s100
v_perm_b32 v245, v62, v58, s100
v_perm_b32 v246, v54, v50, s101
v_perm_b32 v247, v62, v58, s101
v_mfma_f32_16x16x16_bf16 v[168:171], v[218:219], v[240:241], v[168:171]
v_mfma_f32_16x16x16_bf16 v[172:175], v[218:219], v[242:243], v[172:175]
v_perm_b32 v248, v55, v51, s100
v_perm_b32 v249, v63, v59, s100
v_perm_b32 v250, v55, v51, s101
v_perm_b32 v251, v63, v59, s101
v_mfma_f32_16x16x16_bf16 v[176:179], v[218:219], v[244:245], v[176:179]
v_mfma_f32_16x16x16_bf16 v[180:183], v[218:219], v[246:247], v[180:183]
s_nop 1
v_mfma_f32_16x16x16_bf16 v[184:187], v[218:219], v[248:249], v[184:187]
v_mfma_f32_16x16x16_bf16 v[188:191], v[218:219], v[250:251], v[188:191]
s_add_u32 s10, s7, 32768
buffer_load_dwordx4 v[48:51], v6, s[52:55], s10 offen offset:256 nt
buffer_load_dwordx4 v[52:55], v6, s[52:55], s10 offen offset:768 nt
buffer_load_dwordx4 v[56:59], v6, s[52:55], s10 offen offset:1280 nt
buffer_load_dwordx4 v[60:63], v6, s[52:55], s10 offen offset:1792 nt
s_lshl_b32 s10, s8, 7
s_add_u32 s10, s10, 1015808
v_mov_b32 v14, 1
v_mov_b32 v15, 0
s_mov_b64 exec, 1
buffer_atomic_add v14, v15, s[56:59], s10 offen sc0
s_mov_b64 exec, -1
s_waitcnt vmcnt(13)
v_perm_b32 v236, v68, v64, s100
v_perm_b32 v237, v76, v72, s100
v_perm_b32 v238, v68, v64, s101
v_perm_b32 v239, v76, v72, s101
v_perm_b32 v240, v69, v65, s100
v_perm_b32 v241, v77, v73, s100
v_perm_b32 v242, v69, v65, s101
v_perm_b32 v243, v77, v73, s101
v_mfma_f32_16x16x16_bf16 v[128:131], v[220:221], v[236:237], v[128:131]
v_mfma_f32_16x16x16_bf16 v[132:135], v[220:221], v[238:239], v[132:135]
v_perm_b32 v244, v70, v66, s100
v_perm_b32 v245, v78, v74, s100
v_perm_b32 v246, v70, v66, s101
v_perm_b32 v247, v78, v74, s101
v_mfma_f32_16x16x16_bf16 v[136:139], v[220:221], v[240:241], v[136:139]
v_mfma_f32_16x16x16_bf16 v[140:143], v[220:221], v[242:243], v[140:143]
v_perm_b32 v248, v71, v67, s100
v_perm_b32 v249, v79, v75, s100
v_perm_b32 v250, v71, v67, s101
v_perm_b32 v251, v79, v75, s101
v_mfma_f32_16x16x16_bf16 v[144:147], v[220:221], v[244:245], v[144:147]
v_mfma_f32_16x16x16_bf16 v[148:151], v[220:221], v[246:247], v[148:151]
s_nop 1
v_mfma_f32_16x16x16_bf16 v[152:155], v[220:221], v[248:249], v[152:155]
v_mfma_f32_16x16x16_bf16 v[156:159], v[220:221], v[250:251], v[156:159]
s_waitcnt vmcnt(13)
v_perm_b32 v236, v84, v80, s100
v_perm_b32 v237, v92, v88, s100
v_perm_b32 v238, v84, v80, s101
v_perm_b32 v239, v92, v88, s101
v_perm_b32 v240, v85, v81, s100
v_perm_b32 v241, v93, v89, s100
v_perm_b32 v242, v85, v81, s101
v_perm_b32 v243, v93, v89, s101
v_mfma_f32_16x16x16_bf16 v[160:163], v[220:221], v[236:237], v[160:163]
v_mfma_f32_16x16x16_bf16 v[164:167], v[220:221], v[238:239], v[164:167]
v_perm_b32 v244, v86, v82, s100
v_perm_b32 v245, v94, v90, s100
v_perm_b32 v246, v86, v82, s101
v_perm_b32 v247, v94, v90, s101
v_mfma_f32_16x16x16_bf16 v[168:171], v[220:221], v[240:241], v[168:171]
v_mfma_f32_16x16x16_bf16 v[172:175], v[220:221], v[242:243], v[172:175]
v_perm_b32 v248, v87, v83, s100
v_perm_b32 v249, v95, v91, s100
v_perm_b32 v250, v87, v83, s101
v_perm_b32 v251, v95, v91, s101
v_mfma_f32_16x16x16_bf16 v[176:179], v[220:221], v[244:245], v[176:179]
v_mfma_f32_16x16x16_bf16 v[180:183], v[220:221], v[246:247], v[180:183]
s_nop 1
v_mfma_f32_16x16x16_bf16 v[184:187], v[220:221], v[248:249], v[184:187]
v_mfma_f32_16x16x16_bf16 v[188:191], v[220:221], v[250:251], v[188:191]
s_waitcnt vmcnt(13)
v_perm_b32 v236, v100, v96, s100
v_perm_b32 v237, v108, v104, s100
v_perm_b32 v238, v100, v96, s101
v_perm_b32 v239, v108, v104, s101
v_perm_b32 v240, v101, v97, s100
v_perm_b32 v241, v109, v105, s100
v_perm_b32 v242, v101, v97, s101
v_perm_b32 v243, v109, v105, s101
v_mfma_f32_16x16x16_bf16 v[128:131], v[222:223], v[236:237], v[128:131]
v_mfma_f32_16x16x16_bf16 v[132:135], v[222:223], v[238:239], v[132:135]
v_perm_b32 v244, v102, v98, s100
v_perm_b32 v245, v110, v106, s100
v_perm_b32 v246, v102, v98, s101
v_perm_b32 v247, v110, v106, s101
v_mfma_f32_16x16x16_bf16 v[136:139], v[222:223], v[240:241], v[136:139]
v_mfma_f32_16x16x16_bf16 v[140:143], v[222:223], v[242:243], v[140:143]
v_perm_b32 v248, v103, v99, s100
v_perm_b32 v249, v111, v107, s100
v_perm_b32 v250, v103, v99, s101
v_perm_b32 v251, v111, v107, s101
v_mfma_f32_16x16x16_bf16 v[144:147], v[222:223], v[244:245], v[144:147]
v_mfma_f32_16x16x16_bf16 v[148:151], v[222:223], v[246:247], v[148:151]
s_nop 1
v_mfma_f32_16x16x16_bf16 v[152:155], v[222:223], v[248:249], v[152:155]
v_mfma_f32_16x16x16_bf16 v[156:159], v[222:223], v[250:251], v[156:159]
s_waitcnt vmcnt(9)
v_perm_b32 v236, v116, v112, s100
v_perm_b32 v237, v124, v120, s100
v_perm_b32 v238, v116, v112, s101
v_perm_b32 v239, v124, v120, s101
v_perm_b32 v240, v117, v113, s100
v_perm_b32 v241, v125, v121, s100
v_perm_b32 v242, v117, v113, s101
v_perm_b32 v243, v125, v121, s101
v_mfma_f32_16x16x16_bf16 v[160:163], v[222:223], v[236:237], v[160:163]
v_mfma_f32_16x16x16_bf16 v[164:167], v[222:223], v[238:239], v[164:167]
v_perm_b32 v244, v118, v114, s100
v_perm_b32 v245, v126, v122, s100
v_perm_b32 v246, v118, v114, s101
v_perm_b32 v247, v126, v122, s101
v_mfma_f32_16x16x16_bf16 v[168:171], v[222:223], v[240:241], v[168:171]
v_mfma_f32_16x16x16_bf16 v[172:175], v[222:223], v[242:243], v[172:175]
v_perm_b32 v248, v119, v115, s100
v_perm_b32 v249, v127, v123, s100
v_perm_b32 v250, v119, v115, s101
v_perm_b32 v251, v127, v123, s101
v_mfma_f32_16x16x16_bf16 v[176:179], v[222:223], v[244:245], v[176:179]
v_mfma_f32_16x16x16_bf16 v[180:183], v[222:223], v[246:247], v[180:183]
s_nop 1
v_mfma_f32_16x16x16_bf16 v[184:187], v[222:223], v[248:249], v[184:187]
v_mfma_f32_16x16x16_bf16 v[188:191], v[222:223], v[250:251], v[188:191]
s_waitcnt vmcnt(5)
v_perm_b32 v236, v36, v32, s100
v_perm_b32 v237, v44, v40, s100
v_perm_b32 v238, v36, v32, s101
v_perm_b32 v239, v44, v40, s101
v_perm_b32 v240, v37, v33, s100
v_perm_b32 v241, v45, v41, s100
v_perm_b32 v242, v37, v33, s101
v_perm_b32 v243, v45, v41, s101
v_mfma_f32_16x16x16_bf16 v[128:131], v[224:225], v[236:237], v[128:131]
v_mfma_f32_16x16x16_bf16 v[132:135], v[224:225], v[238:239], v[132:135]
v_perm_b32 v244, v38, v34, s100
v_perm_b32 v245, v46, v42, s100
v_perm_b32 v246, v38, v34, s101
v_perm_b32 v247, v46, v42, s101
v_mfma_f32_16x16x16_bf16 v[136:139], v[224:225], v[240:241], v[136:139]
v_mfma_f32_16x16x16_bf16 v[140:143], v[224:225], v[242:243], v[140:143]
v_perm_b32 v248, v39, v35, s100
v_perm_b32 v249, v47, v43, s100
v_perm_b32 v250, v39, v35, s101
v_perm_b32 v251, v47, v43, s101
v_mfma_f32_16x16x16_bf16 v[144:147], v[224:225], v[244:245], v[144:147]
v_mfma_f32_16x16x16_bf16 v[148:151], v[224:225], v[246:247], v[148:151]
s_nop 1
v_mfma_f32_16x16x16_bf16 v[152:155], v[224:225], v[248:249], v[152:155]
v_mfma_f32_16x16x16_bf16 v[156:159], v[224:225], v[250:251], v[156:159]
s_waitcnt vmcnt(1)
v_perm_b32 v236, v52, v48, s100
v_perm_b32 v237, v60, v56, s100
v_perm_b32 v238, v52, v48, s101
v_perm_b32 v239, v60, v56, s101
v_perm_b32 v240, v53, v49, s100
v_perm_b32 v241, v61, v57, s100
v_perm_b32 v242, v53, v49, s101
v_perm_b32 v243, v61, v57, s101
v_mfma_f32_16x16x16_bf16 v[160:163], v[224:225], v[236:237], v[160:163]
v_mfma_f32_16x16x16_bf16 v[164:167], v[224:225], v[238:239], v[164:167]
v_perm_b32 v244, v54, v50, s100
v_perm_b32 v245, v62, v58, s100
v_perm_b32 v246, v54, v50, s101
v_perm_b32 v247, v62, v58, s101
v_mfma_f32_16x16x16_bf16 v[168:171], v[224:225], v[240:241], v[168:171]
v_mfma_f32_16x16x16_bf16 v[172:175], v[224:225], v[242:243], v[172:175]
v_perm_b32 v248, v55, v51, s100
v_perm_b32 v249, v63, v59, s100
v_perm_b32 v250, v55, v51, s101
v_perm_b32 v251, v63, v59, s101
v_mfma_f32_16x16x16_bf16 v[176:179], v[224:225], v[244:245], v[176:179]
v_mfma_f32_16x16x16_bf16 v[180:183], v[224:225], v[246:247], v[180:183]
s_nop 1
v_mfma_f32_16x16x16_bf16 v[184:187], v[224:225], v[248:249], v[184:187]
v_mfma_f32_16x16x16_bf16 v[188:191], v[224:225], v[250:251], v[188:191]
s_branch L_A_dyn
L_A3:
s_waitcnt vmcnt(12)
v_mfma_f32_16x16x32_bf16 v[228:231], v[32:35], v[16:19], 0
v_mfma_f32_16x16x32_bf16 v[228:231], v[36:39], v[20:23], v[228:231]
v_mfma_f32_16x16x32_bf16 v[228:231], v[40:43], v[24:27], v[228:231]
v_mfma_f32_16x16x32_bf16 v[228:231], v[44:47], v[28:31], v[228:231]
s_add_u32 s10, s7, 0
buffer_load_dwordx4 v[32:35], v6, s[52:55], s10 offen offset:0 nt
buffer_load_dwordx4 v[36:39], v6, s[52:55], s10 offen offset:512 nt
buffer_load_dwordx4 v[40:43], v6, s[52:55], s10 offen offset:1024 nt
buffer_load_dwordx4 v[44:47], v6, s[52:55], s10 offen offset:1536 nt
s_waitcnt vmcnt(12)
v_mfma_f32_16x16x32_bf16 v[232:235], v[48:51], v[16:19], 0
v_mfma_f32_16x16x32_bf16 v[232:235], v[52:55], v[20:23], v[232:235]
v_mfma_f32_16x16x32_bf16 v[232:235], v[56:59], v[24:27], v[232:235]
v_mfma_f32_16x16x32_bf16 v[232:235], v[60:63], v[28:31], v[232:235]
s_add_u32 s10, s7, 0
buffer_load_dwordx4 v[48:51], v6, s[52:55], s10 offen offset:256 nt
buffer_load_dwordx4 v[52:55], v6, s[52:55], s10 offen offset:768 nt
buffer_load_dwordx4 v[56:59], v6, s[52:55], s10 offen offset:1280 nt
buffer_load_dwordx4 v[60:63], v6, s[52:55], s10 offen offset:1792 nt
s_nop 7
s_nop 1
v_permlane32_swap_b32 v228, v232
v_permlane32_swap_b32 v229, v233
v_permlane32_swap_b32 v230, v234
v_permlane32_swap_b32 v231, v235
s_nop 0
v_add_f32_dpp v192, v232, v228 quad_perm:[1,0,3,2] row_mask:0xf bank_mask:0xf
v_add_f32_dpp v193, v233, v229 quad_perm:[1,0,3,2] row_mask:0xf bank_mask:0xf
v_add_f32_dpp v194, v234, v230 quad_perm:[1,0,3,2] row_mask:0xf bank_mask:0xf
v_add_f32_dpp v195, v235, v231 quad_perm:[1,0,3,2] row_mask:0xf bank_mask:0xf
v_cvt_pk_bf16_f32 v8, v192, v193
v_cvt_pk_bf16_f32 v9, v194, v195
v_lshlrev_b32 v192, 16, v8
v_and_b32 v193, 0xffff0000, v8
v_lshlrev_b32 v194, 16, v9
v_and_b32 v195, 0xffff0000, v9
s_waitcnt vmcnt(12)
v_mfma_f32_16x16x32_bf16 v[228:231], v[64:67], v[16:19], 0
v_mfma_f32_16x16x32_bf16 v[228:231], v[68:71], v[20:23], v[228:231]
v_mfma_f32_16x16x32_bf16 v[228:231], v[72:75], v[24:27], v[228:231]
v_mfma_f32_16x16x32_bf16 v[228:231], v[76:79], v[28:31], v[228:231]
s_add_u32 s10, s7, 8192
buffer_load_dwordx4 v[64:67], v6, s[52:55], s10 offen offset:0 nt
buffer_load_dwordx4 v[68:71], v6, s[52:55], s10 offen offset:512 nt
buffer_load_dwordx4 v[72:75], v6, s[52:55], s10 offen offset:1024 nt
buffer_load_dwordx4 v[76:79], v6, s[52:55], s10 offen offset:1536 nt
s_waitcnt vmcnt(12)
v_mfma_f32_16x16x32_bf16 v[232:235], v[80:83], v[16:19], 0
v_mfma_f32_16x16x32_bf16 v[232:235], v[84:87], v[20:23], v[232:235]
v_mfma_f32_16x16x32_bf16 v[232:235], v[88:91], v[24:27], v[232:235]
v_mfma_f32_16x16x32_bf16 v[232:235], v[92:95], v[28:31], v[232:235]
s_add_u32 s10, s7, 8192
buffer_load_dwordx4 v[80:83], v6, s[52:55], s10 offen offset:256 nt
buffer_load_dwordx4 v[84:87], v6, s[52:55], s10 offen offset:768 nt
buffer_load_dwordx4 v[88:91], v6, s[52:55], s10 offen offset:1280 nt
buffer_load_dwordx4 v[92:95], v6, s[52:55], s10 offen offset:1792 nt
s_nop 7
s_nop 1
v_permlane32_swap_b32 v228, v232
v_permlane32_swap_b32 v229, v233
v_permlane32_swap_b32 v230, v234
v_permlane32_swap_b32 v231, v235
s_nop 0
v_add_f32_dpp v196, v232, v228 quad_perm:[1,0,3,2] row_mask:0xf bank_mask:0xf
v_add_f32_dpp v197, v233, v229 quad_perm:[1,0,3,2] row_mask:0xf bank_mask:0xf
v_add_f32_dpp v198, v234, v230 quad_perm:[1,0,3,2] row_mask:0xf bank_mask:0xf
v_add_f32_dpp v199, v235, v231 quad_perm:[1,0,3,2] row_mask:0xf bank_mask:0xf
v_cvt_pk_bf16_f32 v8, v196, v197
v_cvt_pk_bf16_f32 v9, v198, v199
v_lshlrev_b32 v196, 16, v8
v_and_b32 v197, 0xffff0000, v8
v_lshlrev_b32 v198, 16, v9
v_and_b32 v199, 0xffff0000, v9
s_waitcnt vmcnt(12)
v_mfma_f32_16x16x32_bf16 v[228:231], v[96:99], v[16:19], 0
v_mfma_f32_16x16x32_bf16 v[228:231], v[100:103], v[20:23], v[228:231]
v_mfma_f32_16x16x32_bf16 v[228:231], v[104:107], v[24:27], v[228:231]
v_mfma_f32_16x16x32_bf16 v[228:231], v[108:111], v[28:31], v[228:231]
s_add_u32 s10, s7, 16384
buffer_load_dwordx4 v[96:99], v6, s[52:55], s10 offen offset:0 nt
buffer_load_dwordx4 v[100:103], v6, s[52:55], s10 offen offset:512 nt
buffer_load_dwordx4 v[104:107], v6, s[52:55], s10 offen offset:1024 nt
buffer_load_dwordx4 v[108:111], v6, s[52:55], s10 offen offset:1536 nt
s_waitcnt vmcnt(12)
v_mfma_f32_16x16x32_bf16 v[232:235], v[112:115], v[16:19], 0
v_mfma_f32_16x16x32_bf16 v[232:235], v[116:119], v[20:23], v[232:235]
v_mfma_f32_16x16x32_bf16 v[232:235], v[120:123], v[24:27], v[232:235]
v_mfma_f32_16x16x32_bf16 v[232:235], v[124:127], v[28:31], v[232:235]
s_add_u32 s10, s7, 16384
buffer_load_dwordx4 v[112:115], v6, s[52:55], s10 offen offset:256 nt
buffer_load_dwordx4 v[116:119], v6, s[52:55], s10 offen offset:768 nt
buffer_load_dwordx4 v[120:123], v6, s[52:55], s10 offen offset:1280 nt
buffer_load_dwordx4 v[124:127], v6, s[52:55], s10 offen offset:1792 nt
s_lshl_b32 s10, s8, 7
s_add_u32 s10, s10, 1015808
v_mov_b32 v14, 1
v_mov_b32 v15, 0
s_mov_b64 exec, 1
buffer_atomic_add v14, v15, s[56:59], s10 offen sc0
s_mov_b64 exec, -1
s_nop 7
s_nop 1
v_permlane32_swap_b32 v228, v232
v_permlane32_swap_b32 v229, v233
v_permlane32_swap_b32 v230, v234
v_permlane32_swap_b32 v231, v235
s_nop 0
v_add_f32_dpp v200, v232, v228 quad_perm:[1,0,3,2] row_mask:0xf bank_mask:0xf
v_add_f32_dpp v201, v233, v229 quad_perm:[1,0,3,2] row_mask:0xf bank_mask:0xf
v_add_f32_dpp v202, v234, v230 quad_perm:[1,0,3,2] row_mask:0xf bank_mask:0xf
v_add_f32_dpp v203, v235, v231 quad_perm:[1,0,3,2] row_mask:0xf bank_mask:0xf
v_cvt_pk_bf16_f32 v8, v200, v201
v_cvt_pk_bf16_f32 v9, v202, v203
v_lshlrev_b32 v200, 16, v8
v_and_b32 v201, 0xffff0000, v8
v_lshlrev_b32 v202, 16, v9
v_and_b32 v203, 0xffff0000, v9
v_max_f32 v12, v192, v193
v_max3_f32 v12, v12, v194, v195
v_max3_f32 v12, v12, v196, v197
v_max3_f32 v12, v12, v198, v199
v_max3_f32 v12, v12, v200, v201
v_max3_f32 v12, v12, v202, v203
v_mov_b32 v8, v12
s_nop 1
v_permlane32_swap_b32 v12, v8
s_nop 1
v_max_f32 v12, v12, v8
v_mov_b32 v8, v12
s_nop 1
v_permlane16_swap_b32 v12, v8
s_nop 1
v_max_f32 v12, v12, v8
v_mul_f32 v9, s15, v12
v_fma_f32 v192, v192, s15, -v9
v_fma_f32 v193, v193, s15, -v9
v_fma_f32 v194, v194, s15, -v9
v_fma_f32 v195, v195, s15, -v9
v_fma_f32 v196, v196, s15, -v9
v_fma_f32 v197, v197, s15, -v9
v_fma_f32 v198, v198, s15, -v9
v_fma_f32 v199, v199, s15, -v9
v_fma_f32 v200, v200, s15, -v9
v_fma_f32 v201, v201, s15, -v9
v_fma_f32 v202, v202, s15, -v9
v_fma_f32 v203, v203, s15, -v9
v_exp_f32 v192, v192
v_exp_f32 v193, v193
v_exp_f32 v194, v194
v_exp_f32 v195, v195
v_exp_f32 v196, v196
v_exp_f32 v197, v197
v_exp_f32 v198, v198
v_exp_f32 v199, v199
v_exp_f32 v200, v200
v_exp_f32 v201, v201
v_exp_f32 v202, v202
v_exp_f32 v203, v203
s_nop 0
v_add_f32 v13, v192, v193
v_add_f32 v13, v13, v194
v_add_f32 v13, v13, v195
v_add_f32 v13, v13, v196
v_add_f32 v13, v13, v197
v_add_f32 v13, v13, v198
v_add_f32 v13, v13, v199
v_add_f32 v13, v13, v200
v_add_f32 v13, v13, v201
v_add_f32 v13, v13, v202
v_add_f32 v13, v13, v203
v_cvt_pk_bf16_f32 v216, v192, v193
v_cvt_pk_bf16_f32 v217, v194, v195
v_cvt_pk_bf16_f32 v218, v196, v197
v_cvt_pk_bf16_f32 v219, v198, v199
v_cvt_pk_bf16_f32 v220, v200, v201
v_cvt_pk_bf16_f32 v221, v202, v203
v_mov_b32 v8, v13
s_nop 1
v_permlane32_swap_b32 v13, v8
s_nop 1
v_add_f32 v13, v13, v8
v_mov_b32 v8, v13
s_nop 1
v_permlane16_swap_b32 v13, v8
s_nop 1
v_add_f32 v13, v13, v8
s_waitcnt vmcnt(13)
v_perm_b32 v236, v36, v32, s100
v_perm_b32 v237, v44, v40, s100
v_perm_b32 v238, v36, v32, s101
v_perm_b32 v239, v44, v40, s101
v_perm_b32 v240, v37, v33, s100
v_perm_b32 v241, v45, v41, s100
v_perm_b32 v242, v37, v33, s101
v_perm_b32 v243, v45, v41, s101
v_mfma_f32_16x16x16_bf16 v[128:131], v[216:217], v[236:237], 0
v_mfma_f32_16x16x16_bf16 v[132:135], v[216:217], v[238:239], 0
v_perm_b32 v244, v38, v34, s100
v_perm_b32 v245, v46, v42, s100
v_perm_b32 v246, v38, v34, s101
v_perm_b32 v247, v46, v42, s101
v_mfma_f32_16x16x16_bf16 v[136:139], v[216:217], v[240:241], 0
v_mfma_f32_16x16x16_bf16 v[140:143], v[216:217], v[242:243], 0
v_perm_b32 v248, v39, v35, s100
v_perm_b32 v249, v47, v43, s100
v_perm_b32 v250, v39, v35, s101
v_perm_b32 v251, v47, v43, s101
v_mfma_f32_16x16x16_bf16 v[144:147], v[216:217], v[244:245], 0
v_mfma_f32_16x16x16_bf16 v[148:151], v[216:217], v[246:247], 0
s_nop 1
v_mfma_f32_16x16x16_bf16 v[152:155], v[216:217], v[248:249], 0
v_mfma_f32_16x16x16_bf16 v[156:159], v[216:217], v[250:251], 0
s_waitcnt vmcnt(13)
v_perm_b32 v236, v52, v48, s100
v_perm_b32 v237, v60, v56, s100
v_perm_b32 v238, v52, v48, s101
v_perm_b32 v239, v60, v56, s101
v_perm_b32 v240, v53, v49, s100
v_perm_b32 v241, v61, v57, s100
v_perm_b32 v242, v53, v49, s101
v_perm_b32 v243, v61, v57, s101
v_mfma_f32_16x16x16_bf16 v[160:163], v[216:217], v[236:237], 0
v_mfma_f32_16x16x16_bf16 v[164:167], v[216:217], v[238:239], 0
v_perm_b32 v244, v54, v50, s100
v_perm_b32 v245, v62, v58, s100
v_perm_b32 v246, v54, v50, s101
v_perm_b32 v247, v62, v58, s101
v_mfma_f32_16x16x16_bf16 v[168:171], v[216:217], v[240:241], 0
v_mfma_f32_16x16x16_bf16 v[172:175], v[216:217], v[242:243], 0
v_perm_b32 v248, v55, v51, s100
v_perm_b32 v249, v63, v59, s100
v_perm_b32 v250, v55, v51, s101
v_perm_b32 v251, v63, v59, s101
v_mfma_f32_16x16x16_bf16 v[176:179], v[216:217], v[244:245], 0
v_mfma_f32_16x16x16_bf16 v[180:183], v[216:217], v[246:247], 0
s_nop 1
v_mfma_f32_16x16x16_bf16 v[184:187], v[216:217], v[248:249], 0
v_mfma_f32_16x16x16_bf16 v[188:191], v[216:217], v[250:251], 0
s_waitcnt vmcnt(13)
v_perm_b32 v236, v68, v64, s100
v_perm_b32 v237, v76, v72, s100
v_perm_b32 v238, v68, v64, s101
v_perm_b32 v239, v76, v72, s101
v_perm_b32 v240, v69, v65, s100
v_perm_b32 v241, v77, v73, s100
v_perm_b32 v242, v69, v65, s101
v_perm_b32 v243, v77, v73, s101
v_mfma_f32_16x16x16_bf16 v[128:131], v[218:219], v[236:237], v[128:131]
v_mfma_f32_16x16x16_bf16 v[132:135], v[218:219], v[238:239], v[132:135]
v_perm_b32 v244, v70, v66, s100
v_perm_b32 v245, v78, v74, s100
v_perm_b32 v246, v70, v66, s101
v_perm_b32 v247, v78, v74, s101
v_mfma_f32_16x16x16_bf16 v[136:139], v[218:219], v[240:241], v[136:139]
v_mfma_f32_16x16x16_bf16 v[140:143], v[218:219], v[242:243], v[140:143]
v_perm_b32 v248, v71, v67, s100
v_perm_b32 v249, v79, v75, s100
v_perm_b32 v250, v71, v67, s101
v_perm_b32 v251, v79, v75, s101
v_mfma_f32_16x16x16_bf16 v[144:147], v[218:219], v[244:245], v[144:147]
v_mfma_f32_16x16x16_bf16 v[148:151], v[218:219], v[246:247], v[148:151]
s_nop 1
v_mfma_f32_16x16x16_bf16 v[152:155], v[218:219], v[248:249], v[152:155]
v_mfma_f32_16x16x16_bf16 v[156:159], v[218:219], v[250:251], v[156:159]
s_waitcnt vmcnt(9)
v_perm_b32 v236, v84, v80, s100
v_perm_b32 v237, v92, v88, s100
v_perm_b32 v238, v84, v80, s101
v_perm_b32 v239, v92, v88, s101
v_perm_b32 v240, v85, v81, s100
v_perm_b32 v241, v93, v89, s100
v_perm_b32 v242, v85, v81, s101
v_perm_b32 v243, v93, v89, s101
v_mfma_f32_16x16x16_bf16 v[160:163], v[218:219], v[236:237], v[160:163]
v_mfma_f32_16x16x16_bf16 v[164:167], v[218:219], v[238:239], v[164:167]
v_perm_b32 v244, v86, v82, s100
v_perm_b32 v245, v94, v90, s100
v_perm_b32 v246, v86, v82, s101
v_perm_b32 v247, v94, v90, s101
v_mfma_f32_16x16x16_bf16 v[168:171], v[218:219], v[240:241], v[168:171]
v_mfma_f32_16x16x16_bf16 v[172:175], v[218:219], v[242:243], v[172:175]
v_perm_b32 v248, v87, v83, s100
v_perm_b32 v249, v95, v91, s100
v_perm_b32 v250, v87, v83, s101
v_perm_b32 v251, v95, v91, s101
v_mfma_f32_16x16x16_bf16 v[176:179], v[218:219], v[244:245], v[176:179]
v_mfma_f32_16x16x16_bf16 v[180:183], v[218:219], v[246:247], v[180:183]
s_nop 1
v_mfma_f32_16x16x16_bf16 v[184:187], v[218:219], v[248:249], v[184:187]
v_mfma_f32_16x16x16_bf16 v[188:191], v[218:219], v[250:251], v[188:191]
s_waitcnt vmcnt(5)
v_perm_b32 v236, v100, v96, s100
v_perm_b32 v237, v108, v104, s100
v_perm_b32 v238, v100, v96, s101
v_perm_b32 v239, v108, v104, s101
v_perm_b32 v240, v101, v97, s100
v_perm_b32 v241, v109, v105, s100
v_perm_b32 v242, v101, v97, s101
v_perm_b32 v243, v109, v105, s101
v_mfma_f32_16x16x16_bf16 v[128:131], v[220:221], v[236:237], v[128:131]
v_mfma_f32_16x16x16_bf16 v[132:135], v[220:221], v[238:239], v[132:135]
v_perm_b32 v244, v102, v98, s100
v_perm_b32 v245, v110, v106, s100
v_perm_b32 v246, v102, v98, s101
v_perm_b32 v247, v110, v106, s101
v_mfma_f32_16x16x16_bf16 v[136:139], v[220:221], v[240:241], v[136:139]
v_mfma_f32_16x16x16_bf16 v[140:143], v[220:221], v[242:243], v[140:143]
v_perm_b32 v248, v103, v99, s100
v_perm_b32 v249, v111, v107, s100
v_perm_b32 v250, v103, v99, s101
v_perm_b32 v251, v111, v107, s101
v_mfma_f32_16x16x16_bf16 v[144:147], v[220:221], v[244:245], v[144:147]
v_mfma_f32_16x16x16_bf16 v[148:151], v[220:221], v[246:247], v[148:151]
s_nop 1
v_mfma_f32_16x16x16_bf16 v[152:155], v[220:221], v[248:249], v[152:155]
v_mfma_f32_16x16x16_bf16 v[156:159], v[220:221], v[250:251], v[156:159]
s_waitcnt vmcnt(1)
v_perm_b32 v236, v116, v112, s100
v_perm_b32 v237, v124, v120, s100
v_perm_b32 v238, v116, v112, s101
v_perm_b32 v239, v124, v120, s101
v_perm_b32 v240, v117, v113, s100
v_perm_b32 v241, v125, v121, s100
v_perm_b32 v242, v117, v113, s101
v_perm_b32 v243, v125, v121, s101
v_mfma_f32_16x16x16_bf16 v[160:163], v[220:221], v[236:237], v[160:163]
v_mfma_f32_16x16x16_bf16 v[164:167], v[220:221], v[238:239], v[164:167]
v_perm_b32 v244, v118, v114, s100
v_perm_b32 v245, v126, v122, s100
v_perm_b32 v246, v118, v114, s101
v_perm_b32 v247, v126, v122, s101
v_mfma_f32_16x16x16_bf16 v[168:171], v[220:221], v[240:241], v[168:171]
v_mfma_f32_16x16x16_bf16 v[172:175], v[220:221], v[242:243], v[172:175]
v_perm_b32 v248, v119, v115, s100
v_perm_b32 v249, v127, v123, s100
v_perm_b32 v250, v119, v115, s101
v_perm_b32 v251, v127, v123, s101
v_mfma_f32_16x16x16_bf16 v[176:179], v[220:221], v[244:245], v[176:179]
v_mfma_f32_16x16x16_bf16 v[180:183], v[220:221], v[246:247], v[180:183]
s_nop 1
v_mfma_f32_16x16x16_bf16 v[184:187], v[220:221], v[248:249], v[184:187]
v_mfma_f32_16x16x16_bf16 v[188:191], v[220:221], v[250:251], v[188:191]
s_branch L_A_dyn
L_A_dyn:
s_waitcnt vmcnt(0)
v_readfirstlane_b32 s11, v14
s_cmp_ge_u32 s11, 48
s_cbranch_scc1 L_A_tail
s_add_u32 s11, s11, 208
s_lshl_b32 s11, s11, 13
s_add_u32 s12, s11, 0x1000
buffer_load_dwordx4 v[32:35], v5, s[48:51], s11 offen offset:0 nt
buffer_load_dwordx4 v[36:39], v5, s[48:51], s11 offen offset:128 nt
buffer_load_dwordx4 v[40:43], v5, s[48:51], s11 offen offset:256 nt
buffer_load_dwordx4 v[44:47], v5, s[48:51], s11 offen offset:384 nt
buffer_load_dwordx4 v[48:51], v5, s[48:51], s12 offen offset:0 nt
buffer_load_dwordx4 v[52:55], v5, s[48:51], s12 offen offset:128 nt
buffer_load_dwordx4 v[56:59], v5, s[48:51], s12 offen offset:256 nt
buffer_load_dwordx4 v[60:63], v5, s[48:51], s12 offen offset:384 nt
buffer_load_dwordx4 v[64:67], v6, s[52:55], s11 offen offset:0 nt
buffer_load_dwordx4 v[68:71], v6, s[52:55], s11 offen offset:512 nt
buffer_load_dwordx4 v[72:75], v6, s[52:55], s11 offen offset:1024 nt
buffer_load_dwordx4 v[76:79], v6, s[52:55], s11 offen offset:1536 nt
buffer_load_dwordx4 v[80:83], v6, s[52:55], s11 offen offset:256 nt
buffer_load_dwordx4 v[84:87], v6, s[52:55], s11 offen offset:768 nt
buffer_load_dwordx4 v[88:91], v6, s[52:55], s11 offen offset:1280 nt
buffer_load_dwordx4 v[92:95], v6, s[52:55], s11 offen offset:1792 nt
s_lshl_b32 s10, s8, 7
s_add_u32 s10, s10, 1015808
v_mov_b32 v14, 1
v_mov_b32 v15, 0
s_mov_b64 exec, 1
buffer_atomic_add v14, v15, s[56:59], s10 offen sc0
s_mov_b64 exec, -1
s_waitcnt vmcnt(9)
v_mfma_f32_16x16x32_bf16 v[228:231], v[32:35], v[16:19], 0
v_mfma_f32_16x16x32_bf16 v[232:235], v[48:51], v[16:19], 0
v_mfma_f32_16x16x32_bf16 v[228:231], v[36:39], v[20:23], v[228:231]
v_mfma_f32_16x16x32_bf16 v[232:235], v[52:55], v[20:23], v[232:235]
v_mfma_f32_16x16x32_bf16 v[228:231], v[40:43], v[24:27], v[228:231]
v_mfma_f32_16x16x32_bf16 v[232:235], v[56:59], v[24:27], v[232:235]
v_mfma_f32_16x16x32_bf16 v[228:231], v[44:47], v[28:31], v[228:231]
v_mfma_f32_16x16x32_bf16 v[232:235], v[60:63], v[28:31], v[232:235]
s_nop 7
s_nop 1
v_permlane32_swap_b32 v228, v232
v_permlane32_swap_b32 v229, v233
v_permlane32_swap_b32 v230, v234
v_permlane32_swap_b32 v231, v235
s_nop 0
v_add_f32_dpp v192, v232, v228 quad_perm:[1,0,3,2] row_mask:0xf bank_mask:0xf
v_add_f32_dpp v193, v233, v229 quad_perm:[1,0,3,2] row_mask:0xf bank_mask:0xf
v_add_f32_dpp v194, v234, v230 quad_perm:[1,0,3,2] row_mask:0xf bank_mask:0xf
v_add_f32_dpp v195, v235, v231 quad_perm:[1,0,3,2] row_mask:0xf bank_mask:0xf
v_cvt_pk_bf16_f32 v8, v192, v193
v_cvt_pk_bf16_f32 v9, v194, v195
v_lshlrev_b32 v192, 16, v8
v_and_b32 v193, 0xffff0000, v8
v_lshlrev_b32 v194, 16, v9
v_and_b32 v195, 0xffff0000, v9
v_max3_f32 v10, v192, v193, v12
v_max3_f32 v10, v10, v194, v195
v_mov_b32 v8, v10
s_nop 1
v_permlane32_swap_b32 v10, v8
s_nop 1
v_max_f32 v10, v10, v8
v_mov_b32 v8, v10
s_nop 1
v_permlane16_swap_b32 v10, v8
s_nop 1
v_max_f32 v10, v10, v8
v_sub_f32 v11, v12, v10
v_mul_f32 v11, s15, v11
v_exp_f32 v11, v11
v_mov_b32 v12, v10
v_mul_f32 v9, s15, v10
v_fma_f32 v192, v192, s15, -v9
v_fma_f32 v193, v193, s15, -v9
v_fma_f32 v194, v194, s15, -v9
v_fma_f32 v195, v195, s15, -v9
v_exp_f32 v192, v192
v_exp_f32 v193, v193
v_exp_f32 v194, v194
v_exp_f32 v195, v195
v_readfirstlane_b32 s12, v11
v_add_f32 v10, v192, v193
v_add_f32 v9, v194, v195
v_add_f32 v10, v10, v9
v_cvt_pk_bf16_f32 v216, v192, v193
v_cvt_pk_bf16_f32 v217, v194, v195
v_mov_b32 v8, v10
s_nop 1
v_permlane32_swap_b32 v10, v8
s_nop 1
v_add_f32 v10, v10, v8
v_mov_b32 v8, v10
s_nop 1
v_permlane16_swap_b32 v10, v8
s_nop 1
v_add_f32 v10, v10, v8
v_fma_f32 v13, v13, v11, v10
v_mul_f32 v128, s12, v128
v_mul_f32 v132, s12, v132
v_mul_f32 v136, s12, v136
v_mul_f32 v140, s12, v140
v_mul_f32 v144, s12, v144
v_mul_f32 v148, s12, v148
v_mul_f32 v152, s12, v152
v_mul_f32 v156, s12, v156
v_mul_f32 v160, s12, v160
v_mul_f32 v164, s12, v164
v_mul_f32 v168, s12, v168
v_mul_f32 v172, s12, v172
v_mul_f32 v176, s12, v176
v_mul_f32 v180, s12, v180
v_mul_f32 v184, s12, v184
v_mul_f32 v188, s12, v188
s_waitcnt vmcnt(1)
v_perm_b32 v236, v68, v64, s100
v_perm_b32 v237, v76, v72, s100
v_perm_b32 v238, v68, v64, s101
v_perm_b32 v239, v76, v72, s101
v_perm_b32 v240, v69, v65, s100
v_perm_b32 v241, v77, v73, s100
v_perm_b32 v242, v69, v65, s101
v_perm_b32 v243, v77, v73, s101
v_mfma_f32_16x16x16_bf16 v[128:131], v[216:217], v[236:237], v[128:131]
v_mfma_f32_16x16x16_bf16 v[132:135], v[216:217], v[238:239], v[132:135]
v_perm_b32 v244, v70, v66, s100
v_perm_b32 v245, v78, v74, s100
v_perm_b32 v246, v70, v66, s101
v_perm_b32 v247, v78, v74, s101
v_mfma_f32_16x16x16_bf16 v[136:139], v[216:217], v[240:241], v[136:139]
v_mfma_f32_16x16x16_bf16 v[140:143], v[216:217], v[242:243], v[140:143]
v_perm_b32 v248, v71, v67, s100
v_perm_b32 v249, v79, v75, s100
v_perm_b32 v250, v71, v67, s101
v_perm_b32 v251, v79, v75, s101
v_mfma_f32_16x16x16_bf16 v[144:147], v[216:217], v[244:245], v[144:147]
v_mfma_f32_16x16x16_bf16 v[148:151], v[216:217], v[246:247], v[148:151]
s_nop 1
v_mfma_f32_16x16x16_bf16 v[152:155], v[216:217], v[248:249], v[152:155]
v_mfma_f32_16x16x16_bf16 v[156:159], v[216:217], v[250:251], v[156:159]
v_perm_b32 v236, v84, v80, s100
v_perm_b32 v237, v92, v88, s100
v_perm_b32 v238, v84, v80, s101
v_perm_b32 v239, v92, v88, s101
v_perm_b32 v240, v85, v81, s100
v_perm_b32 v241, v93, v89, s100
v_perm_b32 v242, v85, v81, s101
v_perm_b32 v243, v93, v89, s101
v_mfma_f32_16x16x16_bf16 v[160:163], v[216:217], v[236:237], v[160:163]
v_mfma_f32_16x16x16_bf16 v[164:167], v[216:217], v[238:239], v[164:167]
v_perm_b32 v244, v86, v82, s100
v_perm_b32 v245, v94, v90, s100
v_perm_b32 v246, v86, v82, s101
v_perm_b32 v247, v94, v90, s101
v_mfma_f32_16x16x16_bf16 v[168:171], v[216:217], v[240:241], v[168:171]
v_mfma_f32_16x16x16_bf16 v[172:175], v[216:217], v[242:243], v[172:175]
v_perm_b32 v248, v87, v83, s100
v_perm_b32 v249, v95, v91, s100
v_perm_b32 v250, v87, v83, s101
v_perm_b32 v251, v95, v91, s101
v_mfma_f32_16x16x16_bf16 v[176:179], v[216:217], v[244:245], v[176:179]
v_mfma_f32_16x16x16_bf16 v[180:183], v[216:217], v[246:247], v[180:183]
s_nop 1
v_mfma_f32_16x16x16_bf16 v[184:187], v[216:217], v[248:249], v[184:187]
v_mfma_f32_16x16x16_bf16 v[188:191], v[216:217], v[250:251], v[188:191]
s_branch L_A_dyn
L_A_tail:
s_nop 7
s_nop 7
v_mov_b32 v32, v128
v_mov_b32 v33, v132
v_mov_b32 v34, v136
v_mov_b32 v35, v140
v_mov_b32 v36, v144
v_mov_b32 v37, v148
v_mov_b32 v38, v152
v_mov_b32 v39, v156
v_mov_b32 v40, v160
v_mov_b32 v41, v164
v_mov_b32 v42, v168
v_mov_b32 v43, v172
v_mov_b32 v44, v176
v_mov_b32 v45, v180
v_mov_b32 v46, v184
v_mov_b32 v47, v188
s_lshl_b32 s10, s3, 10
v_lshlrev_b32 v8, 5, v2
v_add_u32 v8, s10, v8
s_lshl_b32 s11, s3, 3
v_mov_b32 v9, s11
s_mov_b64 exec, 0xffff
ds_write_b128 v8, v[32:35] offset:17408
ds_write_b128 v8, v[36:39] offset:17424
ds_write_b128 v8, v[40:43] offset:17920
ds_write_b128 v8, v[44:47] offset:17936
s_mov_b64 exec, 1
ds_write_b64 v9, v[12:13] offset:25600
s_mov_b64 exec, -1
s_waitcnt lgkmcnt(0)
s_cmp_lt_u32 s6, 4
s_cbranch_scc1 L_A_nfw
s_cmp_lt_u32 s3, 4
s_cbranch_scc1 L_A_nfw
s_and_b32 s68, s96, 1
s_lshr_b32 s69, s96, 3
s_bfe_u32 s70, s96, 0x20001
s_movk_i32 s10, 4682
v_mul_lo_u32 v30, v1, s10
v_lshrrev_b32 v30, 16, v30
v_mul_u32_u24 v31, 14, v30
v_sub_u32 v31, v1, v31
v_mul_u32_u24 v30, 896, v30
v_lshl_add_u32 v30, v31, 4, v30
s_lshl_b32 s10, s69, 9
s_lshl_b32 s11, s3, 6
s_add_u32 s10, s10, s11
s_mul_i32 s10, s10, 896
s_mul_i32 s11, s70, 224
s_add_u32 s10, s10, s11
s_cmp_eq_u32 s68, 1
s_cselect_b32 s44, s36, s24
s_cselect_b32 s45, s37, s25
s_mov_b32 s46, 0x380000
s_mov_b32 s47, 0x20000
s_mul_i32 s11, s3, 64*224
s_add_u32 s11, s11, 40960
s_mov_b32 exec_hi, 0x00ffffff
s_mov_b32 m0, s11
s_nop 0
buffer_load_dwordx4 v30, s[44:47], s10 offen nt lds
s_add_u32 s10, s10, 3584
s_add_u32 s11, s11, 896
s_mov_b32 m0, s11
s_nop 0
buffer_load_dwordx4 v30, s[44:47], s10 offen nt lds
s_add_u32 s10, s10, 3584
s_add_u32 s11, s11, 896
s_mov_b32 m0, s11
s_nop 0
buffer_load_dwordx4 v30, s[44:47], s10 offen nt lds
s_add_u32 s10, s10, 3584
s_add_u32 s11, s11, 896
s_mov_b32 m0, s11
s_nop 0
buffer_load_dwordx4 v30, s[44:47], s10 offen nt lds
s_add_u32 s10, s10, 3584
s_add_u32 s11, s11, 896
s_mov_b32 m0, s11
s_nop 0
buffer_load_dwordx4 v30, s[44:47], s10 offen nt lds
s_add_u32 s10, s10, 3584
s_add_u32 s11, s11, 896
s_mov_b32 m0, s11
s_nop 0
buffer_load_dwordx4 v30, s[44:47], s10 offen nt lds
s_add_u32 s10, s10, 3584
s_add_u32 s11, s11, 896
s_mov_b32 m0, s11
s_nop 0
buffer_load_dwordx4 v30, s[44:47], s10 offen nt lds
s_add_u32 s10, s10, 3584
s_add_u32 s11, s11, 896
s_mov_b32 m0, s11
s_nop 0
buffer_load_dwordx4 v30, s[44:47], s10 offen nt lds
s_add_u32 s10, s10, 3584
s_add_u32 s11, s11, 896
s_mov_b32 m0, s11
s_nop 0
buffer_load_dwordx4 v30, s[44:47], s10 offen nt lds
s_add_u32 s10, s10, 3584
s_add_u32 s11, s11, 896
s_mov_b32 m0, s11
s_nop 0
buffer_load_dwordx4 v30, s[44:47], s10 offen nt lds
s_add_u32 s10, s10, 3584
s_add_u32 s11, s11, 896
s_mov_b32 m0, s11
s_nop 0
buffer_load_dwordx4 v30, s[44:47], s10 offen nt lds
s_add_u32 s10, s10, 3584
s_add_u32 s11, s11, 896
s_mov_b32 m0, s11
s_nop 0
buffer_load_dwordx4 v30, s[44:47], s10 offen nt lds
s_add_u32 s10, s10, 3584
s_add_u32 s11, s11, 896
s_mov_b32 m0, s11
s_nop 0
buffer_load_dwordx4 v30, s[44:47], s10 offen nt lds
s_add_u32 s10, s10, 3584
s_add_u32 s11, s11, 896
s_mov_b32 m0, s11
s_nop 0
buffer_load_dwordx4 v30, s[44:47], s10 offen nt lds
s_add_u32 s10, s10, 3584
s_add_u32 s11, s11, 896
s_mov_b32 m0, s11
s_nop 0
buffer_load_dwordx4 v30, s[44:47], s10 offen nt lds
s_add_u32 s10, s10, 3584
s_add_u32 s11, s11, 896
s_mov_b32 m0, s11
s_nop 0
buffer_load_dwordx4 v30, s[44:47], s10 offen nt lds
s_mov_b64 exec, -1
L_A_nfw:
s_barrier
s_cmp_ge_u32 s3, 4
s_cbranch_scc1 L_A_exit
v_mov_b32 v8, 0
ds_read_b128 v[32:35], v8 offset:25600
ds_read_b128 v[36:39], v8 offset:25616
ds_read_b128 v[40:43], v8 offset:25632
ds_read_b128 v[44:47], v8 offset:25648
ds_read_b32 v15, v8 offset:16896
v_lshlrev_b32 v9, 2, v0
ds_read_b32 v48, v9 offset:17408
ds_read_b32 v49, v9 offset:18432
ds_read_b32 v50, v9 offset:19456
ds_read_b32 v51, v9 offset:20480
ds_read_b32 v52, v9 offset:21504
ds_read_b32 v53, v9 offset:22528
ds_read_b32 v54, v9 offset:23552
ds_read_b32 v55, v9 offset:24576
s_waitcnt lgkmcnt(0)
v_max_f32 v12, v32, v34
v_max3_f32 v12, v12, v36, v38
v_max3_f32 v12, v12, v40, v42
v_max3_f32 v12, v12, v44, v46
v_sub_f32 v32, v32, v12
v_mul_f32 v32, s15, v32
v_exp_f32 v32, v32
v_sub_f32 v34, v34, v12
v_mul_f32 v34, s15, v34
v_exp_f32 v34, v34
v_sub_f32 v36, v36, v12
v_mul_f32 v36, s15, v36
v_exp_f32 v36, v36
v_sub_f32 v38, v38, v12
v_mul_f32 v38, s15, v38
v_exp_f32 v38, v38
v_sub_f32 v40, v40, v12
v_mul_f32 v40, s15, v40
v_exp_f32 v40, v40
v_sub_f32 v42, v42, v12
v_mul_f32 v42, s15, v42
v_exp_f32 v42, v42
v_sub_f32 v44, v44, v12
v_mul_f32 v44, s15, v44
v_exp_f32 v44, v44
v_sub_f32 v46, v46, v12
v_mul_f32 v46, s15, v46
v_exp_f32 v46, v46
s_nop 0
v_mul_f32 v13, v32, v33
v_mul_f32 v14, v32, v48
v_fmac_f32 v13, v34, v35
v_fmac_f32 v14, v34, v49
v_fmac_f32 v13, v36, v37
v_fmac_f32 v14, v36, v50
v_fmac_f32 v13, v38, v39
v_fmac_f32 v14, v38, v51
v_fmac_f32 v13, v40, v41
v_fmac_f32 v14, v40, v52
v_fmac_f32 v13, v42, v43
v_fmac_f32 v14, v42, v53
v_fmac_f32 v13, v44, v45
v_fmac_f32 v14, v44, v54
v_fmac_f32 v13, v46, v47
v_fmac_f32 v14, v46, v55
s_mul_i32 s10, s8, 6
s_add_u32 s10, s10, s6
s_lshl_b32 s11, s10, 12
s_add_u32 s11, s11, 5242880
v_lshlrev_b32 v9, 3, v0
buffer_store_dwordx2 v[14:15], v9, s[56:59], s11 offen sc1
s_cmp_lg_u32 s3, 0
s_cbranch_scc1 L_A_exit
v_mov_b32 v32, v12
v_mov_b32 v33, v15
v_mov_b32 v34, v13
v_mov_b32 v35, v15
s_mov_b64 exec, 1
buffer_store_dwordx4 v[32:35], v8, s[56:59], s11 offen offset:2048 sc1
s_mov_b64 exec, -1
L_A_exit:
s_cmp_lt_u32 s6, 4
s_cbranch_scc1 L_end
s_branch L_F1
L_B1:
s_load_dwordx16 s[16:31], s[0:1], 0
s_load_dwordx8 s[32:39], s[0:1], 64
s_load_dwordx4 s[40:43], s[0:1], 96
s_lshr_b32 s4, s9, 2
s_lshl_b32 s10, s8, 1
s_add_u32 s4, s4, s10
s_and_b32 s14, s9, 3
v_and_b32 v8, 7, v2
v_lshlrev_b32 v5, 13, v8
v_lshrrev_b32 v8, 3, v2
v_lshl_add_u32 v5, v8, 6, v5
v_lshl_add_u32 v5, v3, 4, v5
s_lshl_b32 s10, s14, 8
s_lshl_b32 s11, s3, 5
s_add_u32 s10, s10, s11
s_lshl_b32 s10, s10, 13
s_lshl_b32 s11, s4, 9
s_add_u32 s10, s10, s11
s_waitcnt lgkmcnt(0)
s_mov_b32 s48, s32
s_mov_b32 s49, s33
s_mov_b32 s50, 0x800000
s_mov_b32 s51, 0x20000
s_mov_b32 s56, s42
s_mov_b32 s57, s43
s_mov_b32 s58, 0x10000000
s_mov_b32 s59, 0x20000
s_mov_b32 s60, s40
s_mov_b32 s61, s41
s_mov_b32 s62, 0x100
s_mov_b32 s63, 0x20000
s_or_b32 s11, s2, s3
s_cmp_lg_u32 s11, 0
s_cbranch_scc1 L_B1_nn
s_memrealtime s[12:13]
s_waitcnt lgkmcnt(0)
s_or_b32 s12, s12, 1
v_mov_b32 v10, s12
v_mov_b32 v11, s13
v_mov_b32 v9, 0
s_mov_b64 exec, 1
buffer_store_dwordx2 v[10:11], v9, s[60:63], 0 offen sc1
s_mov_b64 exec, -1
L_B1_nn:
buffer_load_dwordx4 v[32:35], v5, s[48:51], s10 offen offset:0 nt
buffer_load_dwordx4 v[36:39], v5, s[48:51], s10 offen offset:128 nt
buffer_load_dwordx4 v[40:43], v5, s[48:51], s10 offen offset:256 nt
buffer_load_dwordx4 v[44:47], v5, s[48:51], s10 offen offset:384 nt
s_add_u32 s10, s10, 0x10000
s_waitcnt vmcnt(3)
buffer_load_dwordx4 v[48:51], v5, s[48:51], s10 offen offset:0 nt
s_waitcnt vmcnt(3)
buffer_load_dwordx4 v[52:55], v5, s[48:51], s10 offen offset:128 nt
s_waitcnt vmcnt(3)
buffer_load_dwordx4 v[56:59], v5, s[48:51], s10 offen offset:256 nt
s_waitcnt vmcnt(3)
buffer_load_dwordx4 v[60:63], v5, s[48:51], s10 offen offset:384 nt
s_add_u32 s10, s10, 0x10000
s_waitcnt vmcnt(3)
buffer_load_dwordx4 v[64:67], v5, s[48:51], s10 offen offset:0 nt
s_waitcnt vmcnt(3)
buffer_load_dwordx4 v[68:71], v5, s[48:51], s10 offen offset:128 nt
s_waitcnt vmcnt(3)
buffer_load_dwordx4 v[72:75], v5, s[48:51], s10 offen offset:256 nt
s_waitcnt vmcnt(3)
buffer_load_dwordx4 v[76:79], v5, s[48:51], s10 offen offset:384 nt
s_add_u32 s10, s10, 0x10000
s_waitcnt vmcnt(3)
buffer_load_dwordx4 v[80:83], v5, s[48:51], s10 offen offset:0 nt
s_waitcnt vmcnt(3)
buffer_load_dwordx4 v[84:87], v5, s[48:51], s10 offen offset:128 nt
s_waitcnt vmcnt(3)
buffer_load_dwordx4 v[88:91], v5, s[48:51], s10 offen offset:256 nt
s_waitcnt vmcnt(3)
buffer_load_dwordx4 v[92:95], v5, s[48:51], s10 offen offset:384 nt
s_cmp_lg_u32 s3, 0
s_cbranch_scc1 L_pw_qb
v_mov_b32 v9, 0
s_mov_b32 s11, 0
L_nl_qb:
buffer_load_dwordx2 v[10:11], v9, s[60:63], 0 offen sc1
s_waitcnt vmcnt(0)
v_readfirstlane_b32 s94, v10
v_readfirstlane_b32 s95, v11
s_cmp_lg_u64 s[94:95], 0
s_cbranch_scc1 L_nd_qb
s_sleep 4
s_add_u32 s11, s11, 1
s_cmp_lt_u32 s11, 0x40000
s_cbranch_scc1 L_nl_qb
L_nd_qb:
v_lshlrev_b32 v9, 7, v1
s_mov_b32 s10, 0xe2000
s_lshl_b32 s11, s4, 9
s_add_u32 s10, s10, s11
s_mov_b32 s11, 0
s_mov_b64 exec, 0xf
L_pl_qb:
buffer_load_dwordx2 v[10:11], v9, s[56:59], s10 offen sc1
s_waitcnt vmcnt(0)
v_cmp_ne_u64 vcc, s[94:95], v[10:11]
s_cmp_eq_u64 vcc, 0
s_cbranch_scc1 L_pd_qb
s_sleep 24
s_add_u32 s11, s11, 1
s_cmp_lt_u32 s11, 0x40000
s_cbranch_scc1 L_pl_qb
L_pd_qb:
s_mov_b64 exec, -1
L_pw_qb:
s_barrier
v_bfe_u32 v8, v2, 1, 1
v_lshlrev_b32 v8, 13, v8
v_and_b32 v9, 1, v2
v_lshl_add_u32 v8, v9, 6, v8
v_lshl_add_u32 v8, v3, 4, v8
s_lshl_b32 s10, s4, 9
s_add_u32 s10, s10, 737280
buffer_load_dwordx4 v[16:19], v8, s[56:59], s10 offen offset:0 sc1
buffer_load_dwordx4 v[20:23], v8, s[56:59], s10 offen offset:128 sc1
buffer_load_dwordx4 v[24:27], v8, s[56:59], s10 offen offset:256 sc1
buffer_load_dwordx4 v[28:31], v8, s[56:59], s10 offen offset:384 sc1
s_waitcnt vmcnt(0)
v_mfma_f32_16x16x32_bf16 v[96:99], v[32:35], v[16:19], 0
v_mfma_f32_16x16x32_bf16 v[100:103], v[48:51], v[16:19], 0
v_mfma_f32_16x16x32_bf16 v[104:107], v[64:67], v[16:19], 0
v_mfma_f32_16x16x32_bf16 v[108:111], v[80:83], v[16:19], 0
v_mfma_f32_16x16x32_bf16 v[96:99], v[36:39], v[20:23], v[96:99]
v_mfma_f32_16x16x32_bf16 v[100:103], v[52:55], v[20:23], v[100:103]
v_mfma_f32_16x16x32_bf16 v[104:107], v[68:71], v[20:23], v[104:107]
v_mfma_f32_16x16x32_bf16 v[108:111], v[84:87], v[20:23], v[108:111]
v_mfma_f32_16x16x32_bf16 v[96:99], v[40:43], v[24:27], v[96:99]
v_mfma_f32_16x16x32_bf16 v[100:103], v[56:59], v[24:27], v[100:103]
v_mfma_f32_16x16x32_bf16 v[104:107], v[72:75], v[24:27], v[104:107]
v_mfma_f32_16x16x32_bf16 v[108:111], v[88:91], v[24:27], v[108:111]
v_mfma_f32_16x16x32_bf16 v[96:99], v[44:47], v[28:31], v[96:99]
v_mfma_f32_16x16x32_bf16 v[100:103], v[60:63], v[28:31], v[100:103]
v_mfma_f32_16x16x32_bf16 v[104:107], v[76:79], v[28:31], v[104:107]
v_mfma_f32_16x16x32_bf16 v[108:111], v[92:95], v[28:31], v[108:111]
s_nop 7
s_nop 1
v_permlane32_swap_b32 v96, v100
v_permlane32_swap_b32 v97, v101
v_permlane32_swap_b32 v98, v102
v_permlane32_swap_b32 v99, v103
v_permlane32_swap_b32 v104, v108
v_permlane32_swap_b32 v105, v109
v_permlane32_swap_b32 v106, v110
v_permlane32_swap_b32 v107, v111
s_nop 0
v_add_f32_dpp v112, v100, v96 quad_perm:[1,0,3,2] row_mask:0xf bank_mask:0xf
v_add_f32_dpp v113, v101, v97 quad_perm:[1,0,3,2] row_mask:0xf bank_mask:0xf
v_add_f32_dpp v114, v102, v98 quad_perm:[1,0,3,2] row_mask:0xf bank_mask:0xf
v_add_f32_dpp v115, v103, v99 quad_perm:[1,0,3,2] row_mask:0xf bank_mask:0xf
v_add_f32_dpp v116, v108, v104 quad_perm:[1,0,3,2] row_mask:0xf bank_mask:0xf
v_add_f32_dpp v117, v109, v105 quad_perm:[1,0,3,2] row_mask:0xf bank_mask:0xf
v_add_f32_dpp v118, v110, v106 quad_perm:[1,0,3,2] row_mask:0xf bank_mask:0xf
v_add_f32_dpp v119, v111, v107 quad_perm:[1,0,3,2] row_mask:0xf bank_mask:0xf
v_cvt_pk_bf16_f32 v32, v112, v113
v_cvt_pk_bf16_f32 v33, v114, v115
v_lshlrev_b32 v8, 16, v32
v_sub_f32 v112, v112, v8
v_and_b32 v8, 0xffff0000, v32
v_sub_f32 v113, v113, v8
v_lshlrev_b32 v8, 16, v33
v_sub_f32 v114, v114, v8
v_and_b32 v8, 0xffff0000, v33
v_sub_f32 v115, v115, v8
v_cvt_pk_bf16_f32 v36, v112, v113
v_cvt_pk_bf16_f32 v37, v114, v115
v_cvt_pk_bf16_f32 v34, v116, v117
v_cvt_pk_bf16_f32 v35, v118, v119
v_lshlrev_b32 v8, 16, v34
v_sub_f32 v116, v116, v8
v_and_b32 v8, 0xffff0000, v34
v_sub_f32 v117, v117, v8
v_lshlrev_b32 v8, 16, v35
v_sub_f32 v118, v118, v8
v_and_b32 v8, 0xffff0000, v35
v_sub_f32 v119, v119, v8
v_cvt_pk_bf16_f32 v38, v116, v117
v_cvt_pk_bf16_f32 v39, v118, v119
v_bfe_u32 v8, v2, 1, 1
v_lshlrev_b32 v8, 10, v8
v_lshl_add_u32 v8, v3, 3, v8
s_lshl_b32 s10, s3, 6
v_add_u32 v8, s10, v8
s_mov_b32 exec_lo, 0x00050005
s_mov_b32 exec_hi, 0x00050005
ds_write_b64 v8, v[32:33] offset:33792
ds_write_b64 v8, v[36:37] offset:34304
ds_write_b64 v8, v[34:35] offset:33824
ds_write_b64 v8, v[38:39] offset:34336
s_mov_b64 exec, -1
s_waitcnt lgkmcnt(0)
s_barrier
s_cmp_lg_u32 s3, 0
s_cbranch_scc1 L_B1_done
v_lshlrev_b32 v8, 4, v1
ds_read_b128 v[32:35], v8 offset:33792
ds_read_b128 v[36:39], v8 offset:34816
v_lshrrev_b32 v8, 5, v1
v_lshlrev_b32 v8, 15, v8
v_and_b32 v9, 31, v1
v_lshl_add_u32 v8, v9, 4, v8
s_lshl_b32 s10, s4, 11
s_lshl_b32 s11, s14, 9
s_add_u32 s10, s10, s11
s_add_u32 s10, s10, 262144
s_add_u32 s11, s10, 0x10000
s_waitcnt lgkmcnt(0)
buffer_store_dwordx4 v[32:35], v8, s[56:59], s10 offen sc1
buffer_store_dwordx4 v[36:39], v8, s[56:59], s11 offen sc1
s_waitcnt vmcnt(0)
s_lshl_b32 s12, s4, 2
s_add_u32 s12, s12, s14
v_mov_b32 v10, s94
v_mov_b32 v11, s95
s_lshl_b32 s10, s12, 7
s_add_u32 s10, s10, 0xe4000
v_mov_b32 v9, 0
s_mov_b64 exec, 1
buffer_store_dwordx2 v[10:11], v9, s[56:59], s10 offen sc1
s_mov_b64 exec, -1
L_B1_done:
s_lshl_b32 s96, s4, 2
s_add_u32 s96, s96, s14
s_and_b32 s8, s2, 7
s_lshr_b32 s9, s2, 3
s_lshl_b32 s10, s9, 1
s_bfe_u32 s11, s8, 0x10001
s_add_u32 s10, s10, s11
s_lshl_b32 s10, s10, 1
s_lshr_b32 s11, s8, 2
s_xor_b32 s11, s11, 1
s_add_u32 s10, s10, s11
s_and_b32 s4, s10, 15
s_lshr_b32 s5, s10, 4
s_and_b32 s6, s8, 1
s_mul_i32 s7, s6, 24
s_add_u32 s7, s7, 160
s_mul_i32 s10, s3, 3
s_add_u32 s7, s7, s10
s_add_u32 s6, s6, 4
s_sub_u32 s10, s3, 1
s_max_i32 s10, s10, 0
s_min_u32 s10, s10, 0
s_add_u32 s7, s7, s10
s_sub_u32 s10, s3, 1
s_cmp_lt_u32 s10, 0
s_cselect_b32 s14, 4, 3
s_load_dwordx16 s[16:31], s[0:1], 0
s_load_dwordx8 s[32:39], s[0:1], 64
s_load_dwordx4 s[40:43], s[0:1], 96
s_lshl_b32 s7, s7, 13
s_lshl_b32 s8, s5, 4
s_add_u32 s8, s8, s4
s_lshl_b32 s9, s8, 21
v_and_b32 v8, 7, v2
v_lshlrev_b32 v5, 9, v8
v_lshrrev_b32 v8, 3, v2
v_lshl_add_u32 v5, v8, 6, v5
v_lshl_add_u32 v5, v3, 4, v5
v_lshlrev_b32 v6, 11, v3
v_lshl_add_u32 v6, v2, 4, v6
s_waitcnt lgkmcnt(0)
s_add_u32 s48, s18, s9
s_addc_u32 s49, s19, 0
s_mov_b32 s50, 0x200000
s_mov_b32 s51, 0x20000
s_add_u32 s52, s20, s9
s_addc_u32 s53, s21, 0
s_mov_b32 s54, 0x200000
s_mov_b32 s55, 0x20000
s_mov_b32 s56, s42
s_mov_b32 s57, s43
s_mov_b32 s58, 0x10000000
s_mov_b32 s59, 0x20000
s_mov_b32 s60, s40
s_mov_b32 s61, s41
s_mov_b32 s62, 0x100
s_mov_b32 s63, 0x20000
s_mov_b32 s100, 0x05040100
s_mov_b32 s101, 0x07060302
s_mov_b32 s15, 0x3db8aa3b
s_branch L_A_head
L_B2:
s_load_dwordx16 s[16:31], s[0:1], 0
s_load_dwordx8 s[32:39], s[0:1], 64
s_load_dwordx4 s[40:43], s[0:1], 96
s_sub_u32 s9, s9, 8
s_lshl_b32 s9, s9, 3
s_add_u32 s9, s9, s8
s_lshr_b32 s5, s9, 5
s_and_b32 s6, s9, 31
s_lshr_b32 s4, s9, 2
s_and_b32 s14, s9, 3
s_mov_b32 s15, 0x3db8aa3b
s_waitcnt lgkmcnt(0)
s_mov_b32 s44, s28
s_mov_b32 s45, s29
s_mov_b32 s46, 0x1000000
s_mov_b32 s47, 0x20000
s_mov_b32 s48, s34
s_mov_b32 s49, s35
s_mov_b32 s50, 0x800000
s_mov_b32 s51, 0x20000
s_mov_b32 s56, s42
s_mov_b32 s57, s43
s_mov_b32 s58, 0x10000000
s_mov_b32 s59, 0x20000
s_mov_b32 s60, s40
s_mov_b32 s61, s41
s_mov_b32 s62, 0x100
s_mov_b32 s63, 0x20000
v_and_b32 v8, 7, v2
v_lshlrev_b32 v5, 11, v8
v_lshrrev_b32 v8, 3, v2
v_lshl_add_u32 v5, v8, 6, v5
v_lshl_add_u32 v5, v3, 4, v5
s_lshl_b32 s10, s9, 18
s_lshl_b32 s11, s3, 8
s_add_u32 s10, s10, s11
buffer_load_dwordx4 v[128:131], v5, s[44:47], s10 offen offset:0 nt
buffer_load_dwordx4 v[132:135], v5, s[44:47], s10 offen offset:128 nt
s_add_u32 s10, s10, 0x4000
buffer_load_dwordx4 v[136:139], v5, s[44:47], s10 offen offset:0 nt
buffer_load_dwordx4 v[140:143], v5, s[44:47], s10 offen offset:128 nt
s_add_u32 s10, s10, 0x4000
s_waitcnt vmcnt(3)
buffer_load_dwordx4 v[144:147], v5, s[44:47], s10 offen offset:0 nt
s_waitcnt vmcnt(3)
buffer_load_dwordx4 v[148:151], v5, s[44:47], s10 offen offset:128 nt
s_add_u32 s10, s10, 0x4000
s_waitcnt vmcnt(3)
buffer_load_dwordx4 v[152:155], v5, s[44:47], s10 offen offset:0 nt
s_waitcnt vmcnt(3)
buffer_load_dwordx4 v[156:159], v5, s[44:47], s10 offen offset:128 nt
s_add_u32 s10, s10, 0x4000
s_waitcnt vmcnt(3)
buffer_load_dwordx4 v[160:163], v5, s[44:47], s10 offen offset:0 nt
s_waitcnt vmcnt(3)
buffer_load_dwordx4 v[164:167], v5, s[44:47], s10 offen offset:128 nt
s_add_u32 s10, s10, 0x4000
s_waitcnt vmcnt(3)
buffer_load_dwordx4 v[168:171], v5, s[44:47], s10 offen offset:0 nt
s_waitcnt vmcnt(3)
buffer_load_dwordx4 v[172:175], v5, s[44:47], s10 offen offset:128 nt
s_add_u32 s10, s10, 0x4000
s_waitcnt vmcnt(3)
buffer_load_dwordx4 v[176:179], v5, s[44:47], s10 offen offset:0 nt
s_waitcnt vmcnt(3)
buffer_load_dwordx4 v[180:183], v5, s[44:47], s10 offen offset:128 nt
s_add_u32 s10, s10, 0x4000
s_waitcnt vmcnt(3)
buffer_load_dwordx4 v[184:187], v5, s[44:47], s10 offen offset:0 nt
s_waitcnt vmcnt(3)
buffer_load_dwordx4 v[188:191], v5, s[44:47], s10 offen offset:128 nt
s_add_u32 s10, s10, 0x4000
s_waitcnt vmcnt(3)
buffer_load_dwordx4 v[192:195], v5, s[44:47], s10 offen offset:0 nt
s_waitcnt vmcnt(3)
buffer_load_dwordx4 v[196:199], v5, s[44:47], s10 offen offset:128 nt
s_add_u32 s10, s10, 0x4000
s_waitcnt vmcnt(3)
buffer_load_dwordx4 v[200:203], v5, s[44:47], s10 offen offset:0 nt
s_waitcnt vmcnt(3)
buffer_load_dwordx4 v[204:207], v5, s[44:47], s10 offen offset:128 nt
s_add_u32 s10, s10, 0x4000
s_waitcnt vmcnt(3)
buffer_load_dwordx4 v[208:211], v5, s[44:47], s10 offen offset:0 nt
s_waitcnt vmcnt(3)
buffer_load_dwordx4 v[212:215], v5, s[44:47], s10 offen offset:128 nt
s_add_u32 s10, s10, 0x4000
s_waitcnt vmcnt(3)
buffer_load_dwordx4 v[216:219], v5, s[44:47], s10 offen offset:0 nt
s_waitcnt vmcnt(3)
buffer_load_dwordx4 v[220:223], v5, s[44:47], s10 offen offset:128 nt
s_add_u32 s10, s10, 0x4000
s_waitcnt vmcnt(3)
buffer_load_dwordx4 v[224:227], v5, s[44:47], s10 offen offset:0 nt
s_waitcnt vmcnt(3)
buffer_load_dwordx4 v[228:231], v5, s[44:47], s10 offen offset:128 nt
s_add_u32 s10, s10, 0x4000
s_waitcnt vmcnt(3)
buffer_load_dwordx4 v[232:235], v5, s[44:47], s10 offen offset:0 nt
s_waitcnt vmcnt(3)
buffer_load_dwordx4 v[236:239], v5, s[44:47], s10 offen offset:128 nt
s_add_u32 s10, s10, 0x4000
s_waitcnt vmcnt(3)
buffer_load_dwordx4 v[240:243], v5, s[44:47], s10 offen offset:0 nt
s_waitcnt vmcnt(3)
buffer_load_dwordx4 v[244:247], v5, s[44:47], s10 offen offset:128 nt
s_add_u32 s10, s10, 0x4000
s_waitcnt vmcnt(3)
buffer_load_dwordx4 v[248:251], v5, s[44:47], s10 offen offset:0 nt
s_waitcnt vmcnt(3)
buffer_load_dwordx4 v[252:255], v5, s[44:47], s10 offen offset:128 nt
v_lshrrev_b32 v7, 5, v1
v_lshlrev_b32 v4, 13, v7
v_and_b32 v8, 31, v1
v_lshl_add_u32 v4, v8, 4, v4
s_lshl_b32 s10, s14, 8
s_lshl_b32 s11, s3, 5
s_add_u32 s10, s10, s11
s_lshl_b32 s10, s10, 13
s_lshl_b32 s11, s4, 9
s_add_u32 s10, s10, s11
s_lshl_b32 s11, s3, 13
s_add_u32 s11, s11, 0x10000
s_mov_b32 m0, s11
s_waitcnt vmcnt(3)
buffer_load_dwordx4 v4, s[48:51], s10 offen nt lds
s_add_u32 s10, s10, 0x4000
s_add_u32 s11, s11, 0x400
s_mov_b32 m0, s11
s_waitcnt vmcnt(3)
buffer_load_dwordx4 v4, s[48:51], s10 offen nt lds
s_add_u32 s10, s10, 0x4000
s_add_u32 s11, s11, 0x400
s_mov_b32 m0, s11
s_waitcnt vmcnt(3)
buffer_load_dwordx4 v4, s[48:51], s10 offen nt lds
s_add_u32 s10, s10, 0x4000
s_add_u32 s11, s11, 0x400
s_mov_b32 m0, s11
s_waitcnt vmcnt(3)
buffer_load_dwordx4 v4, s[48:51], s10 offen nt lds
s_add_u32 s10, s10, 0x4000
s_add_u32 s11, s11, 0x400
s_mov_b32 m0, s11
s_waitcnt vmcnt(3)
buffer_load_dwordx4 v4, s[48:51], s10 offen nt lds
s_add_u32 s10, s10, 0x4000
s_add_u32 s11, s11, 0x400
s_mov_b32 m0, s11
s_waitcnt vmcnt(3)
buffer_load_dwordx4 v4, s[48:51], s10 offen nt lds
s_add_u32 s10, s10, 0x4000
s_add_u32 s11, s11, 0x400
s_mov_b32 m0, s11
s_waitcnt vmcnt(3)
buffer_load_dwordx4 v4, s[48:51], s10 offen nt lds
s_add_u32 s10, s10, 0x4000
s_add_u32 s11, s11, 0x400
s_mov_b32 m0, s11
s_waitcnt vmcnt(3)
buffer_load_dwordx4 v4, s[48:51], s10 offen nt lds
s_add_u32 s10, s10, 0x4000
s_mov_b32 s97, s10
v_lshrrev_b32 v8, 3, v2
v_sub_u32 v8, v3, v8
v_lshlrev_b32 v8, 2, v8
v_bfe_u32 v9, v2, 1, 2
v_add_u32 v8, v8, v9
v_and_b32 v9, 1, v2
v_lshlrev_b32 v9, 4, v9
v_mov_b32 v10, 0x3f80
v_lshlrev_b32 v9, v9, v10
v_cmp_eq_u32 vcc, 0, v8
s_nop 1
v_cndmask_b32 v16, 0, v9, vcc
v_cmp_eq_u32 vcc, 1, v8
s_nop 1
v_cndmask_b32 v17, 0, v9, vcc
v_cmp_eq_u32 vcc, 2, v8
s_nop 1
v_cndmask_b32 v18, 0, v9, vcc
v_cmp_eq_u32 vcc, 3, v8
s_nop 1
v_cndmask_b32 v19, 0, v9, vcc
v_cmp_eq_u32 vcc, 8, v8
s_nop 1
v_cndmask_b32 v20, 0, v9, vcc
v_cmp_eq_u32 vcc, 9, v8
s_nop 1
v_cndmask_b32 v21, 0, v9, vcc
v_cmp_eq_u32 vcc, 10, v8
s_nop 1
v_cndmask_b32 v22, 0, v9, vcc
v_cmp_eq_u32 vcc, 11, v8
s_nop 1
v_cndmask_b32 v23, 0, v9, vcc
s_waitcnt lgkmcnt(0)
s_cmp_lg_u32 s3, 0
s_cbranch_scc1 L_pw_q
v_mov_b32 v9, 0
s_mov_b32 s11, 0
L_nl_q:
buffer_load_dwordx2 v[10:11], v9, s[60:63], 0 offen sc1
s_waitcnt vmcnt(0)
v_readfirstlane_b32 s94, v10
v_readfirstlane_b32 s95, v11
s_cmp_lg_u64 s[94:95], 0
s_cbranch_scc1 L_nd_q
s_sleep 4
s_add_u32 s11, s11, 1
s_cmp_lt_u32 s11, 0x40000
s_cbranch_scc1 L_nl_q
L_nd_q:
v_lshlrev_b32 v9, 7, v1
s_mov_b32 s10, 0xe4000
s_mov_b32 s11, 0
L_pl_q:
buffer_load_dwordx2 v[10:11], v9, s[56:59], s10 offen sc1
s_waitcnt vmcnt(0)
v_cmp_ne_u64 vcc, s[94:95], v[10:11]
s_cmp_eq_u64 vcc, 0
s_cbranch_scc1 L_pd_q
s_sleep 24
s_add_u32 s11, s11, 1
s_cmp_lt_u32 s11, 0x40000
s_cbranch_scc1 L_pl_q
L_pd_q:
s_mov_b64 exec, -1
L_pw_q:
s_barrier
s_cmp_lg_u32 s3, 0
s_cbranch_scc1 L_B2_nt
v_mov_b32 v8, s94
v_mov_b32 v9, 141312
ds_write_b32 v9, v8
L_B2_nt:
v_lshrrev_b32 v8, 1, v2
v_lshlrev_b32 v6, 11, v8
v_and_b32 v8, 1, v2
v_lshl_add_u32 v6, v8, 6, v6
v_lshl_add_u32 v6, v3, 4, v6
s_lshl_b32 s10, s5, 16
s_lshl_b32 s11, s3, 8
s_add_u32 s10, s10, s11
s_add_u32 s10, s10, 262144
s_add_u32 s11, s10, 0
buffer_load_dwordx4 v[32:35], v6, s[56:59], s11 offen offset:0 sc1
buffer_load_dwordx4 v[48:51], v6, s[56:59], s11 offen offset:128 sc1
s_add_u32 s11, s10, 32768
buffer_load_dwordx4 v[36:39], v6, s[56:59], s11 offen offset:0 sc1
buffer_load_dwordx4 v[52:55], v6, s[56:59], s11 offen offset:128 sc1
s_add_u32 s11, s10, 16384
buffer_load_dwordx4 v[40:43], v6, s[56:59], s11 offen offset:0 sc1
buffer_load_dwordx4 v[56:59], v6, s[56:59], s11 offen offset:128 sc1
s_add_u32 s11, s10, 49152
buffer_load_dwordx4 v[44:47], v6, s[56:59], s11 offen offset:0 sc1
buffer_load_dwordx4 v[60:63], v6, s[56:59], s11 offen offset:128 sc1
v_and_b32 v8, 1, v1
v_cmp_eq_u32 s[98:99], 1, v8
v_lshlrev_b32 v11, 4, v1
s_lshl_b32 s11, s3, 13
v_add_u32 v15, s11, v11
s_waitcnt vmcnt(0)
v_mfma_f32_16x16x32_bf16 v[64:67], v[128:131], v[32:35], 0
v_mfma_f32_16x16x32_bf16 v[68:71], v[136:139], v[32:35], 0
v_mfma_f32_16x16x32_bf16 v[72:75], v[128:131], v[40:43], 0
v_mfma_f32_16x16x32_bf16 v[76:79], v[136:139], v[40:43], 0
v_mfma_f32_16x16x32_bf16 v[64:67], v[128:131], v[36:39], v[64:67]
v_mfma_f32_16x16x32_bf16 v[68:71], v[136:139], v[36:39], v[68:71]
v_mfma_f32_16x16x32_bf16 v[72:75], v[128:131], v[44:47], v[72:75]
v_mfma_f32_16x16x32_bf16 v[76:79], v[136:139], v[44:47], v[76:79]
v_mfma_f32_16x16x32_bf16 v[64:67], v[132:135], v[48:51], v[64:67]
v_mfma_f32_16x16x32_bf16 v[68:71], v[140:143], v[48:51], v[68:71]
v_mfma_f32_16x16x32_bf16 v[72:75], v[132:135], v[56:59], v[72:75]
v_mfma_f32_16x16x32_bf16 v[76:79], v[140:143], v[56:59], v[76:79]
v_mfma_f32_16x16x32_bf16 v[64:67], v[132:135], v[52:55], v[64:67]
v_mfma_f32_16x16x32_bf16 v[68:71], v[140:143], v[52:55], v[68:71]
v_mfma_f32_16x16x32_bf16 v[72:75], v[132:135], v[60:63], v[72:75]
v_mfma_f32_16x16x32_bf16 v[76:79], v[140:143], v[60:63], v[76:79]
s_nop 7
s_nop 1
v_permlane32_swap_b32 v64, v68
v_permlane32_swap_b32 v65, v69
v_permlane32_swap_b32 v66, v70
v_permlane32_swap_b32 v67, v71
v_permlane32_swap_b32 v72, v76
v_permlane32_swap_b32 v73, v77
v_permlane32_swap_b32 v74, v78
v_permlane32_swap_b32 v75, v79
s_nop 0
v_add_f32_dpp v64, v68, v64 quad_perm:[1,0,3,2] row_mask:0xf bank_mask:0xf
v_add_f32_dpp v76, v72, v76 quad_perm:[1,0,3,2] row_mask:0xf bank_mask:0xf
v_add_f32_dpp v65, v69, v65 quad_perm:[1,0,3,2] row_mask:0xf bank_mask:0xf
v_add_f32_dpp v77, v73, v77 quad_perm:[1,0,3,2] row_mask:0xf bank_mask:0xf
v_add_f32_dpp v66, v70, v66 quad_perm:[1,0,3,2] row_mask:0xf bank_mask:0xf
v_add_f32_dpp v78, v74, v78 quad_perm:[1,0,3,2] row_mask:0xf bank_mask:0xf
v_add_f32_dpp v67, v71, v67 quad_perm:[1,0,3,2] row_mask:0xf bank_mask:0xf
v_add_f32_dpp v79, v75, v79 quad_perm:[1,0,3,2] row_mask:0xf bank_mask:0xf
v_cndmask_b32 v80, v64, v76, s[98:99]
v_cndmask_b32 v81, v65, v77, s[98:99]
v_cndmask_b32 v82, v66, v78, s[98:99]
v_cndmask_b32 v83, v67, v79, s[98:99]
ds_write_b128 v15, v[80:83] offset:0
v_mfma_f32_16x16x32_bf16 v[64:67], v[144:147], v[32:35], 0
v_mfma_f32_16x16x32_bf16 v[68:71], v[152:155], v[32:35], 0
v_mfma_f32_16x16x32_bf16 v[72:75], v[144:147], v[40:43], 0
v_mfma_f32_16x16x32_bf16 v[76:79], v[152:155], v[40:43], 0
v_mfma_f32_16x16x32_bf16 v[64:67], v[144:147], v[36:39], v[64:67]
v_mfma_f32_16x16x32_bf16 v[68:71], v[152:155], v[36:39], v[68:71]
v_mfma_f32_16x16x32_bf16 v[72:75], v[144:147], v[44:47], v[72:75]
v_mfma_f32_16x16x32_bf16 v[76:79], v[152:155], v[44:47], v[76:79]
v_mfma_f32_16x16x32_bf16 v[64:67], v[148:151], v[48:51], v[64:67]
v_mfma_f32_16x16x32_bf16 v[68:71], v[156:159], v[48:51], v[68:71]
v_mfma_f32_16x16x32_bf16 v[72:75], v[148:151], v[56:59], v[72:75]
v_mfma_f32_16x16x32_bf16 v[76:79], v[156:159], v[56:59], v[76:79]
v_mfma_f32_16x16x32_bf16 v[64:67], v[148:151], v[52:55], v[64:67]
v_mfma_f32_16x16x32_bf16 v[68:71], v[156:159], v[52:55], v[68:71]
v_mfma_f32_16x16x32_bf16 v[72:75], v[148:151], v[60:63], v[72:75]
v_mfma_f32_16x16x32_bf16 v[76:79], v[156:159], v[60:63], v[76:79]
s_nop 7
s_nop 1
v_permlane32_swap_b32 v64, v68
v_permlane32_swap_b32 v65, v69
v_permlane32_swap_b32 v66, v70
v_permlane32_swap_b32 v67, v71
v_permlane32_swap_b32 v72, v76
v_permlane32_swap_b32 v73, v77
v_permlane32_swap_b32 v74, v78
v_permlane32_swap_b32 v75, v79
s_nop 0
v_add_f32_dpp v64, v68, v64 quad_perm:[1,0,3,2] row_mask:0xf bank_mask:0xf
v_add_f32_dpp v76, v72, v76 quad_perm:[1,0,3,2] row_mask:0xf bank_mask:0xf
v_add_f32_dpp v65, v69, v65 quad_perm:[1,0,3,2] row_mask:0xf bank_mask:0xf
v_add_f32_dpp v77, v73, v77 quad_perm:[1,0,3,2] row_mask:0xf bank_mask:0xf
v_add_f32_dpp v66, v70, v66 quad_perm:[1,0,3,2] row_mask:0xf bank_mask:0xf
v_add_f32_dpp v78, v74, v78 quad_perm:[1,0,3,2] row_mask:0xf bank_mask:0xf
v_add_f32_dpp v67, v71, v67 quad_perm:[1,0,3,2] row_mask:0xf bank_mask:0xf
v_add_f32_dpp v79, v75, v79 quad_perm:[1,0,3,2] row_mask:0xf bank_mask:0xf
v_cndmask_b32 v84, v64, v76, s[98:99]
v_cndmask_b32 v85, v65, v77, s[98:99]
v_cndmask_b32 v86, v66, v78, s[98:99]
v_cndmask_b32 v87, v67, v79, s[98:99]
ds_write_b128 v15, v[84:87] offset:1024
v_mfma_f32_16x16x32_bf16 v[64:67], v[160:163], v[32:35], 0
v_mfma_f32_16x16x32_bf16 v[68:71], v[168:171], v[32:35], 0
v_mfma_f32_16x16x32_bf16 v[72:75], v[160:163], v[40:43], 0
v_mfma_f32_16x16x32_bf16 v[76:79], v[168:171], v[40:43], 0
v_mfma_f32_16x16x32_bf16 v[64:67], v[160:163], v[36:39], v[64:67]
v_mfma_f32_16x16x32_bf16 v[68:71], v[168:171], v[36:39], v[68:71]
v_mfma_f32_16x16x32_bf16 v[72:75], v[160:163], v[44:47], v[72:75]
v_mfma_f32_16x16x32_bf16 v[76:79], v[168:171], v[44:47], v[76:79]
v_mfma_f32_16x16x32_bf16 v[64:67], v[164:167], v[48:51], v[64:67]
v_mfma_f32_16x16x32_bf16 v[68:71], v[172:175], v[48:51], v[68:71]
v_mfma_f32_16x16x32_bf16 v[72:75], v[164:167], v[56:59], v[72:75]
v_mfma_f32_16x16x32_bf16 v[76:79], v[172:175], v[56:59], v[76:79]
v_mfma_f32_16x16x32_bf16 v[64:67], v[164:167], v[52:55], v[64:67]
v_mfma_f32_16x16x32_bf16 v[68:71], v[172:175], v[52:55], v[68:71]
v_mfma_f32_16x16x32_bf16 v[72:75], v[164:167], v[60:63], v[72:75]
v_mfma_f32_16x16x32_bf16 v[76:79], v[172:175], v[60:63], v[76:79]
s_nop 7
s_nop 1
v_permlane32_swap_b32 v64, v68
v_permlane32_swap_b32 v65, v69
v_permlane32_swap_b32 v66, v70
v_permlane32_swap_b32 v67, v71
v_permlane32_swap_b32 v72, v76
v_permlane32_swap_b32 v73, v77
v_permlane32_swap_b32 v74, v78
v_permlane32_swap_b32 v75, v79
s_nop 0
v_add_f32_dpp v64, v68, v64 quad_perm:[1,0,3,2] row_mask:0xf bank_mask:0xf
v_add_f32_dpp v76, v72, v76 quad_perm:[1,0,3,2] row_mask:0xf bank_mask:0xf
v_add_f32_dpp v65, v69, v65 quad_perm:[1,0,3,2] row_mask:0xf bank_mask:0xf
v_add_f32_dpp v77, v73, v77 quad_perm:[1,0,3,2] row_mask:0xf bank_mask:0xf
v_add_f32_dpp v66, v70, v66 quad_perm:[1,0,3,2] row_mask:0xf bank_mask:0xf
v_add_f32_dpp v78, v74, v78 quad_perm:[1,0,3,2] row_mask:0xf bank_mask:0xf
v_add_f32_dpp v67, v71, v67 quad_perm:[1,0,3,2] row_mask:0xf bank_mask:0xf
v_add_f32_dpp v79, v75, v79 quad_perm:[1,0,3,2] row_mask:0xf bank_mask:0xf
v_cndmask_b32 v88, v64, v76, s[98:99]
v_cndmask_b32 v89, v65, v77, s[98:99]
v_cndmask_b32 v90, v66, v78, s[98:99]
v_cndmask_b32 v91, v67, v79, s[98:99]
ds_write_b128 v15, v[88:91] offset:2048
v_mfma_f32_16x16x32_bf16 v[64:67], v[176:179], v[32:35], 0
v_mfma_f32_16x16x32_bf16 v[68:71], v[184:187], v[32:35], 0
v_mfma_f32_16x16x32_bf16 v[72:75], v[176:179], v[40:43], 0
v_mfma_f32_16x16x32_bf16 v[76:79], v[184:187], v[40:43], 0
v_mfma_f32_16x16x32_bf16 v[64:67], v[176:179], v[36:39], v[64:67]
v_mfma_f32_16x16x32_bf16 v[68:71], v[184:187], v[36:39], v[68:71]
v_mfma_f32_16x16x32_bf16 v[72:75], v[176:179], v[44:47], v[72:75]
v_mfma_f32_16x16x32_bf16 v[76:79], v[184:187], v[44:47], v[76:79]
v_mfma_f32_16x16x32_bf16 v[64:67], v[180:183], v[48:51], v[64:67]
v_mfma_f32_16x16x32_bf16 v[68:71], v[188:191], v[48:51], v[68:71]
v_mfma_f32_16x16x32_bf16 v[72:75], v[180:183], v[56:59], v[72:75]
v_mfma_f32_16x16x32_bf16 v[76:79], v[188:191], v[56:59], v[76:79]
v_mfma_f32_16x16x32_bf16 v[64:67], v[180:183], v[52:55], v[64:67]
v_mfma_f32_16x16x32_bf16 v[68:71], v[188:191], v[52:55], v[68:71]
v_mfma_f32_16x16x32_bf16 v[72:75], v[180:183], v[60:63], v[72:75]
v_mfma_f32_16x16x32_bf16 v[76:79], v[188:191], v[60:63], v[76:79]
s_nop 7
s_nop 1
v_permlane32_swap_b32 v64, v68
v_permlane32_swap_b32 v65, v69
v_permlane32_swap_b32 v66, v70
v_permlane32_swap_b32 v67, v71
v_permlane32_swap_b32 v72, v76
v_permlane32_swap_b32 v73, v77
v_permlane32_swap_b32 v74, v78
v_permlane32_swap_b32 v75, v79
s_nop 0
v_add_f32_dpp v64, v68, v64 quad_perm:[1,0,3,2] row_mask:0xf bank_mask:0xf
v_add_f32_dpp v76, v72, v76 quad_perm:[1,0,3,2] row_mask:0xf bank_mask:0xf
v_add_f32_dpp v65, v69, v65 quad_perm:[1,0,3,2] row_mask:0xf bank_mask:0xf
v_add_f32_dpp v77, v73, v77 quad_perm:[1,0,3,2] row_mask:0xf bank_mask:0xf
v_add_f32_dpp v66, v70, v66 quad_perm:[1,0,3,2] row_mask:0xf bank_mask:0xf
v_add_f32_dpp v78, v74, v78 quad_perm:[1,0,3,2] row_mask:0xf bank_mask:0xf
v_add_f32_dpp v67, v71, v67 quad_perm:[1,0,3,2] row_mask:0xf bank_mask:0xf
v_add_f32_dpp v79, v75, v79 quad_perm:[1,0,3,2] row_mask:0xf bank_mask:0xf
v_cndmask_b32 v92, v64, v76, s[98:99]
v_cndmask_b32 v93, v65, v77, s[98:99]
v_cndmask_b32 v94, v66, v78, s[98:99]
v_cndmask_b32 v95, v67, v79, s[98:99]
ds_write_b128 v15, v[92:95] offset:3072
v_mfma_f32_16x16x32_bf16 v[64:67], v[192:195], v[32:35], 0
v_mfma_f32_16x16x32_bf16 v[68:71], v[200:203], v[32:35], 0
v_mfma_f32_16x16x32_bf16 v[72:75], v[192:195], v[40:43], 0
v_mfma_f32_16x16x32_bf16 v[76:79], v[200:203], v[40:43], 0
v_mfma_f32_16x16x32_bf16 v[64:67], v[192:195], v[36:39], v[64:67]
v_mfma_f32_16x16x32_bf16 v[68:71], v[200:203], v[36:39], v[68:71]
v_mfma_f32_16x16x32_bf16 v[72:75], v[192:195], v[44:47], v[72:75]
v_mfma_f32_16x16x32_bf16 v[76:79], v[200:203], v[44:47], v[76:79]
v_mfma_f32_16x16x32_bf16 v[64:67], v[196:199], v[48:51], v[64:67]
v_mfma_f32_16x16x32_bf16 v[68:71], v[204:207], v[48:51], v[68:71]
v_mfma_f32_16x16x32_bf16 v[72:75], v[196:199], v[56:59], v[72:75]
v_mfma_f32_16x16x32_bf16 v[76:79], v[204:207], v[56:59], v[76:79]
v_mfma_f32_16x16x32_bf16 v[64:67], v[196:199], v[52:55], v[64:67]
v_mfma_f32_16x16x32_bf16 v[68:71], v[204:207], v[52:55], v[68:71]
v_mfma_f32_16x16x32_bf16 v[72:75], v[196:199], v[60:63], v[72:75]
v_mfma_f32_16x16x32_bf16 v[76:79], v[204:207], v[60:63], v[76:79]
s_nop 7
s_nop 1
v_permlane32_swap_b32 v64, v68
v_permlane32_swap_b32 v65, v69
v_permlane32_swap_b32 v66, v70
v_permlane32_swap_b32 v67, v71
v_permlane32_swap_b32 v72, v76
v_permlane32_swap_b32 v73, v77
v_permlane32_swap_b32 v74, v78
v_permlane32_swap_b32 v75, v79
s_nop 0
v_add_f32_dpp v64, v68, v64 quad_perm:[1,0,3,2] row_mask:0xf bank_mask:0xf
v_add_f32_dpp v76, v72, v76 quad_perm:[1,0,3,2] row_mask:0xf bank_mask:0xf
v_add_f32_dpp v65, v69, v65 quad_perm:[1,0,3,2] row_mask:0xf bank_mask:0xf
v_add_f32_dpp v77, v73, v77 quad_perm:[1,0,3,2] row_mask:0xf bank_mask:0xf
v_add_f32_dpp v66, v70, v66 quad_perm:[1,0,3,2] row_mask:0xf bank_mask:0xf
v_add_f32_dpp v78, v74, v78 quad_perm:[1,0,3,2] row_mask:0xf bank_mask:0xf
v_add_f32_dpp v67, v71, v67 quad_perm:[1,0,3,2] row_mask:0xf bank_mask:0xf
v_add_f32_dpp v79, v75, v79 quad_perm:[1,0,3,2] row_mask:0xf bank_mask:0xf
v_cndmask_b32 v96, v64, v76, s[98:99]
v_cndmask_b32 v97, v65, v77, s[98:99]
v_cndmask_b32 v98, v66, v78, s[98:99]
v_cndmask_b32 v99, v67, v79, s[98:99]
ds_write_b128 v15, v[96:99] offset:4096
v_mfma_f32_16x16x32_bf16 v[64:67], v[208:211], v[32:35], 0
v_mfma_f32_16x16x32_bf16 v[68:71], v[216:219], v[32:35], 0
v_mfma_f32_16x16x32_bf16 v[72:75], v[208:211], v[40:43], 0
v_mfma_f32_16x16x32_bf16 v[76:79], v[216:219], v[40:43], 0
v_mfma_f32_16x16x32_bf16 v[64:67], v[208:211], v[36:39], v[64:67]
v_mfma_f32_16x16x32_bf16 v[68:71], v[216:219], v[36:39], v[68:71]
v_mfma_f32_16x16x32_bf16 v[72:75], v[208:211], v[44:47], v[72:75]
v_mfma_f32_16x16x32_bf16 v[76:79], v[216:219], v[44:47], v[76:79]
v_mfma_f32_16x16x32_bf16 v[64:67], v[212:215], v[48:51], v[64:67]
v_mfma_f32_16x16x32_bf16 v[68:71], v[220:223], v[48:51], v[68:71]
v_mfma_f32_16x16x32_bf16 v[72:75], v[212:215], v[56:59], v[72:75]
v_mfma_f32_16x16x32_bf16 v[76:79], v[220:223], v[56:59], v[76:79]
v_mfma_f32_16x16x32_bf16 v[64:67], v[212:215], v[52:55], v[64:67]
v_mfma_f32_16x16x32_bf16 v[68:71], v[220:223], v[52:55], v[68:71]
v_mfma_f32_16x16x32_bf16 v[72:75], v[212:215], v[60:63], v[72:75]
v_mfma_f32_16x16x32_bf16 v[76:79], v[220:223], v[60:63], v[76:79]
s_nop 7
s_nop 1
v_permlane32_swap_b32 v64, v68
v_permlane32_swap_b32 v65, v69
v_permlane32_swap_b32 v66, v70
v_permlane32_swap_b32 v67, v71
v_permlane32_swap_b32 v72, v76
v_permlane32_swap_b32 v73, v77
v_permlane32_swap_b32 v74, v78
v_permlane32_swap_b32 v75, v79
s_nop 0
v_add_f32_dpp v64, v68, v64 quad_perm:[1,0,3,2] row_mask:0xf bank_mask:0xf
v_add_f32_dpp v76, v72, v76 quad_perm:[1,0,3,2] row_mask:0xf bank_mask:0xf
v_add_f32_dpp v65, v69, v65 quad_perm:[1,0,3,2] row_mask:0xf bank_mask:0xf
v_add_f32_dpp v77, v73, v77 quad_perm:[1,0,3,2] row_mask:0xf bank_mask:0xf
v_add_f32_dpp v66, v70, v66 quad_perm:[1,0,3,2] row_mask:0xf bank_mask:0xf
v_add_f32_dpp v78, v74, v78 quad_perm:[1,0,3,2] row_mask:0xf bank_mask:0xf
v_add_f32_dpp v67, v71, v67 quad_perm:[1,0,3,2] row_mask:0xf bank_mask:0xf
v_add_f32_dpp v79, v75, v79 quad_perm:[1,0,3,2] row_mask:0xf bank_mask:0xf
v_cndmask_b32 v100, v64, v76, s[98:99]
v_cndmask_b32 v101, v65, v77, s[98:99]
v_cndmask_b32 v102, v66, v78, s[98:99]
v_cndmask_b32 v103, v67, v79, s[98:99]
ds_write_b128 v15, v[100:103] offset:5120
v_mfma_f32_16x16x32_bf16 v[64:67], v[224:227], v[32:35], 0
v_mfma_f32_16x16x32_bf16 v[68:71], v[232:235], v[32:35], 0
v_mfma_f32_16x16x32_bf16 v[72:75], v[224:227], v[40:43], 0
v_mfma_f32_16x16x32_bf16 v[76:79], v[232:235], v[40:43], 0
v_mfma_f32_16x16x32_bf16 v[64:67], v[224:227], v[36:39], v[64:67]
v_mfma_f32_16x16x32_bf16 v[68:71], v[232:235], v[36:39], v[68:71]
v_mfma_f32_16x16x32_bf16 v[72:75], v[224:227], v[44:47], v[72:75]
v_mfma_f32_16x16x32_bf16 v[76:79], v[232:235], v[44:47], v[76:79]
v_mfma_f32_16x16x32_bf16 v[64:67], v[228:231], v[48:51], v[64:67]
v_mfma_f32_16x16x32_bf16 v[68:71], v[236:239], v[48:51], v[68:71]
v_mfma_f32_16x16x32_bf16 v[72:75], v[228:231], v[56:59], v[72:75]
v_mfma_f32_16x16x32_bf16 v[76:79], v[236:239], v[56:59], v[76:79]
v_mfma_f32_16x16x32_bf16 v[64:67], v[228:231], v[52:55], v[64:67]
v_mfma_f32_16x16x32_bf16 v[68:71], v[236:239], v[52:55], v[68:71]
v_mfma_f32_16x16x32_bf16 v[72:75], v[228:231], v[60:63], v[72:75]
v_mfma_f32_16x16x32_bf16 v[76:79], v[236:239], v[60:63], v[76:79]
s_nop 7
s_nop 1
v_permlane32_swap_b32 v64, v68
v_permlane32_swap_b32 v65, v69
v_permlane32_swap_b32 v66, v70
v_permlane32_swap_b32 v67, v71
v_permlane32_swap_b32 v72, v76
v_permlane32_swap_b32 v73, v77
v_permlane32_swap_b32 v74, v78
v_permlane32_swap_b32 v75, v79
s_nop 0
v_add_f32_dpp v64, v68, v64 quad_perm:[1,0,3,2] row_mask:0xf bank_mask:0xf
v_add_f32_dpp v76, v72, v76 quad_perm:[1,0,3,2] row_mask:0xf bank_mask:0xf
v_add_f32_dpp v65, v69, v65 quad_perm:[1,0,3,2] row_mask:0xf bank_mask:0xf
v_add_f32_dpp v77, v73, v77 quad_perm:[1,0,3,2] row_mask:0xf bank_mask:0xf
v_add_f32_dpp v66, v70, v66 quad_perm:[1,0,3,2] row_mask:0xf bank_mask:0xf
v_add_f32_dpp v78, v74, v78 quad_perm:[1,0,3,2] row_mask:0xf bank_mask:0xf
v_add_f32_dpp v67, v71, v67 quad_perm:[1,0,3,2] row_mask:0xf bank_mask:0xf
v_add_f32_dpp v79, v75, v79 quad_perm:[1,0,3,2] row_mask:0xf bank_mask:0xf
v_cndmask_b32 v104, v64, v76, s[98:99]
v_cndmask_b32 v105, v65, v77, s[98:99]
v_cndmask_b32 v106, v66, v78, s[98:99]
v_cndmask_b32 v107, v67, v79, s[98:99]
ds_write_b128 v15, v[104:107] offset:6144
v_mfma_f32_16x16x32_bf16 v[64:67], v[240:243], v[32:35], 0
v_mfma_f32_16x16x32_bf16 v[68:71], v[248:251], v[32:35], 0
v_mfma_f32_16x16x32_bf16 v[72:75], v[240:243], v[40:43], 0
v_mfma_f32_16x16x32_bf16 v[76:79], v[248:251], v[40:43], 0
v_mfma_f32_16x16x32_bf16 v[64:67], v[240:243], v[36:39], v[64:67]
v_mfma_f32_16x16x32_bf16 v[68:71], v[248:251], v[36:39], v[68:71]
v_mfma_f32_16x16x32_bf16 v[72:75], v[240:243], v[44:47], v[72:75]
v_mfma_f32_16x16x32_bf16 v[76:79], v[248:251], v[44:47], v[76:79]
v_mfma_f32_16x16x32_bf16 v[64:67], v[244:247], v[48:51], v[64:67]
v_mfma_f32_16x16x32_bf16 v[68:71], v[252:255], v[48:51], v[68:71]
v_mfma_f32_16x16x32_bf16 v[72:75], v[244:247], v[56:59], v[72:75]
v_mfma_f32_16x16x32_bf16 v[76:79], v[252:255], v[56:59], v[76:79]
v_mfma_f32_16x16x32_bf16 v[64:67], v[244:247], v[52:55], v[64:67]
v_mfma_f32_16x16x32_bf16 v[68:71], v[252:255], v[52:55], v[68:71]
v_mfma_f32_16x16x32_bf16 v[72:75], v[244:247], v[60:63], v[72:75]
v_mfma_f32_16x16x32_bf16 v[76:79], v[252:255], v[60:63], v[76:79]
s_nop 7
s_nop 1
v_permlane32_swap_b32 v64, v68
v_permlane32_swap_b32 v65, v69
v_permlane32_swap_b32 v66, v70
v_permlane32_swap_b32 v67, v71
v_permlane32_swap_b32 v72, v76
v_permlane32_swap_b32 v73, v77
v_permlane32_swap_b32 v74, v78
v_permlane32_swap_b32 v75, v79
s_nop 0
v_add_f32_dpp v64, v68, v64 quad_perm:[1,0,3,2] row_mask:0xf bank_mask:0xf
v_add_f32_dpp v76, v72, v76 quad_perm:[1,0,3,2] row_mask:0xf bank_mask:0xf
v_add_f32_dpp v65, v69, v65 quad_perm:[1,0,3,2] row_mask:0xf bank_mask:0xf
v_add_f32_dpp v77, v73, v77 quad_perm:[1,0,3,2] row_mask:0xf bank_mask:0xf
v_add_f32_dpp v66, v70, v66 quad_perm:[1,0,3,2] row_mask:0xf bank_mask:0xf
v_add_f32_dpp v78, v74, v78 quad_perm:[1,0,3,2] row_mask:0xf bank_mask:0xf
v_add_f32_dpp v67, v71, v67 quad_perm:[1,0,3,2] row_mask:0xf bank_mask:0xf
v_add_f32_dpp v79, v75, v79 quad_perm:[1,0,3,2] row_mask:0xf bank_mask:0xf
v_cndmask_b32 v108, v64, v76, s[98:99]
v_cndmask_b32 v109, v65, v77, s[98:99]
v_cndmask_b32 v110, v66, v78, s[98:99]
v_cndmask_b32 v111, v67, v79, s[98:99]
ds_write_b128 v15, v[108:111] offset:7168
s_waitcnt lgkmcnt(0)
s_barrier
s_lshl_b32 s11, s3, 10
v_add_u32 v15, s11, v11
ds_read_b128 v[80:83], v15 offset:0
ds_read_b128 v[84:87], v15 offset:8192
ds_read_b128 v[88:91], v15 offset:16384
ds_read_b128 v[92:95], v15 offset:24576
ds_read_b128 v[96:99], v15 offset:32768
ds_read_b128 v[100:103], v15 offset:40960
ds_read_b128 v[104:107], v15 offset:49152
ds_read_b128 v[108:111], v15 offset:57344
s_waitcnt lgkmcnt(0)
v_add_f32 v80, v80, v96
v_add_f32 v81, v81, v97
v_add_f32 v82, v82, v98
v_add_f32 v83, v83, v99
v_add_f32 v84, v84, v100
v_add_f32 v85, v85, v101
v_add_f32 v86, v86, v102
v_add_f32 v87, v87, v103
v_add_f32 v88, v88, v104
v_add_f32 v89, v89, v105
v_add_f32 v90, v90, v106
v_add_f32 v91, v91, v107
v_add_f32 v92, v92, v108
v_add_f32 v93, v93, v109
v_add_f32 v94, v94, v110
v_add_f32 v95, v95, v111
v_add_f32 v80, v80, v88
v_add_f32 v81, v81, v89
v_add_f32 v82, v82, v90
v_add_f32 v83, v83, v91
v_add_f32 v84, v84, v92
v_add_f32 v85, v85, v93
v_add_f32 v86, v86, v94
v_add_f32 v87, v87, v95
v_add_f32 v80, v80, v84
v_add_f32 v81, v81, v85
v_add_f32 v82, v82, v86
v_add_f32 v83, v83, v87
v_add_u32 v15, 131072, v15
ds_write_b128 v15, v[80:83]
v_add_u32 v11, 131072, v11
s_waitcnt lgkmcnt(0)
s_barrier
ds_read_b128 v[80:83], v11 offset:0
ds_read_b128 v[84:87], v11 offset:1024
ds_read_b128 v[88:91], v11 offset:2048
ds_read_b128 v[92:95], v11 offset:3072
ds_read_b128 v[96:99], v11 offset:4096
ds_read_b128 v[100:103], v11 offset:5120
ds_read_b128 v[104:107], v11 offset:6144
ds_read_b128 v[108:111], v11 offset:7168
s_waitcnt lgkmcnt(0)
v_max_f32 v12, v80, v81
v_max3_f32 v12, v12, v82, v83
v_max3_f32 v12, v12, v84, v85
v_max3_f32 v12, v12, v86, v87
v_max3_f32 v12, v12, v88, v89
v_max3_f32 v12, v12, v90, v91
v_max3_f32 v12, v12, v92, v93
v_max3_f32 v12, v12, v94, v95
v_max3_f32 v12, v12, v96, v97
v_max3_f32 v12, v12, v98, v99
v_max3_f32 v12, v12, v100, v101
v_max3_f32 v12, v12, v102, v103
v_max3_f32 v12, v12, v104, v105
v_max3_f32 v12, v12, v106, v107
v_max3_f32 v12, v12, v108, v109
v_max3_f32 v12, v12, v110, v111
v_mov_b32 v8, v12
s_nop 1
v_permlane32_swap_b32 v12, v8
s_nop 1
v_max_f32 v12, v12, v8
v_mov_b32 v8, v12
s_nop 1
v_permlane16_swap_b32 v12, v8
s_nop 1
v_max_f32 v12, v12, v8
v_mul_f32 v9, s15, v12
v_fma_f32 v80, v80, s15, -v9
v_fma_f32 v81, v81, s15, -v9
v_fma_f32 v82, v82, s15, -v9
v_fma_f32 v83, v83, s15, -v9
v_fma_f32 v84, v84, s15, -v9
v_fma_f32 v85, v85, s15, -v9
v_fma_f32 v86, v86, s15, -v9
v_fma_f32 v87, v87, s15, -v9
v_fma_f32 v88, v88, s15, -v9
v_fma_f32 v89, v89, s15, -v9
v_fma_f32 v90, v90, s15, -v9
v_fma_f32 v91, v91, s15, -v9
v_fma_f32 v92, v92, s15, -v9
v_fma_f32 v93, v93, s15, -v9
v_fma_f32 v94, v94, s15, -v9
v_fma_f32 v95, v95, s15, -v9
v_fma_f32 v96, v96, s15, -v9
v_fma_f32 v97, v97, s15, -v9
v_fma_f32 v98, v98, s15, -v9
v_fma_f32 v99, v99, s15, -v9
v_fma_f32 v100, v100, s15, -v9
v_fma_f32 v101, v101, s15, -v9
v_fma_f32 v102, v102, s15, -v9
v_fma_f32 v103, v103, s15, -v9
v_fma_f32 v104, v104, s15, -v9
v_fma_f32 v105, v105, s15, -v9
v_fma_f32 v106, v106, s15, -v9
v_fma_f32 v107, v107, s15, -v9
v_fma_f32 v108, v108, s15, -v9
v_fma_f32 v109, v109, s15, -v9
v_fma_f32 v110, v110, s15, -v9
v_fma_f32 v111, v111, s15, -v9
v_exp_f32 v80, v80
v_exp_f32 v81, v81
v_exp_f32 v82, v82
v_exp_f32 v83, v83
v_exp_f32 v84, v84
v_exp_f32 v85, v85
v_exp_f32 v86, v86
v_exp_f32 v87, v87
v_exp_f32 v88, v88
v_exp_f32 v89, v89
v_exp_f32 v90, v90
v_exp_f32 v91, v91
v_exp_f32 v92, v92
v_exp_f32 v93, v93
v_exp_f32 v94, v94
v_exp_f32 v95, v95
v_exp_f32 v96, v96
v_exp_f32 v97, v97
v_exp_f32 v98, v98
v_exp_f32 v99, v99
v_exp_f32 v100, v100
v_exp_f32 v101, v101
v_exp_f32 v102, v102
v_exp_f32 v103, v103
v_exp_f32 v104, v104
v_exp_f32 v105, v105
v_exp_f32 v106, v106
v_exp_f32 v107, v107
v_exp_f32 v108, v108
v_exp_f32 v109, v109
v_exp_f32 v110, v110
v_exp_f32 v111, v111
s_nop 0
v_add_f32 v13, v80, v81
v_add_f32 v13, v13, v82
v_add_f32 v13, v13, v83
v_add_f32 v13, v13, v84
v_add_f32 v13, v13, v85
v_add_f32 v13, v13, v86
v_add_f32 v13, v13, v87
v_add_f32 v13, v13, v88
v_add_f32 v13, v13, v89
v_add_f32 v13, v13, v90
v_add_f32 v13, v13, v91
v_add_f32 v13, v13, v92
v_add_f32 v13, v13, v93
v_add_f32 v13, v13, v94
v_add_f32 v13, v13, v95
v_add_f32 v13, v13, v96
v_add_f32 v13, v13, v97
v_add_f32 v13, v13, v98
v_add_f32 v13, v13, v99
v_add_f32 v13, v13, v100
v_add_f32 v13, v13, v101
v_add_f32 v13, v13, v102
v_add_f32 v13, v13, v103
v_add_f32 v13, v13, v104
v_add_f32 v13, v13, v105
v_add_f32 v13, v13, v106
v_add_f32 v13, v13, v107
v_add_f32 v13, v13, v108
v_add_f32 v13, v13, v109
v_add_f32 v13, v13, v110
v_add_f32 v13, v13, v111
v_cvt_pk_bf16_f32 v112, v80, v81
v_cvt_pk_bf16_f32 v113, v82, v83
v_cvt_pk_bf16_f32 v114, v84, v85
v_cvt_pk_bf16_f32 v115, v86, v87
v_cvt_pk_bf16_f32 v116, v88, v89
v_cvt_pk_bf16_f32 v117, v90, v91
v_cvt_pk_bf16_f32 v118, v92, v93
v_cvt_pk_bf16_f32 v119, v94, v95
v_cvt_pk_bf16_f32 v120, v96, v97
v_cvt_pk_bf16_f32 v121, v98, v99
v_cvt_pk_bf16_f32 v122, v100, v101
v_cvt_pk_bf16_f32 v123, v102, v103
v_cvt_pk_bf16_f32 v124, v104, v105
v_cvt_pk_bf16_f32 v125, v106, v107
v_cvt_pk_bf16_f32 v126, v108, v109
v_cvt_pk_bf16_f32 v127, v110, v111
v_mov_b32 v8, v13
s_nop 1
v_permlane32_swap_b32 v13, v8
s_nop 1
v_add_f32 v13, v13, v8
v_mov_b32 v8, v13
s_nop 1
v_permlane16_swap_b32 v13, v8
s_nop 1
v_add_f32 v13, v13, v8
v_lshrrev_b32 v14, 1, v2
v_and_b32 v8, 1, v2
v_lshl_add_u32 v14, v8, 3, v14
s_cmp_lg_u32 s3, 0
s_cbranch_scc1 L_B2_nostat
v_lshlrev_b32 v8, 3, v14
s_lshl_b32 s10, s9, 7
s_add_u32 s10, s10, 393216
s_mov_b64 exec, 0xffff
buffer_store_dwordx2 v[12:13], v8, s[56:59], s10 offen sc1
s_mov_b64 exec, -1
L_B2_nostat:
v_mfma_f32_16x16x32_bf16 v[64:67], v[128:131], v[16:19], 0
v_mfma_f32_16x16x32_bf16 v[68:71], v[136:139], v[16:19], 0
s_nop 1
s_nop 1
s_nop 3
v_mfma_f32_16x16x32_bf16 v[72:75], v[128:131], v[20:23], 0
v_mfma_f32_16x16x32_bf16 v[76:79], v[136:139], v[20:23], 0
s_nop 1
s_nop 1
s_nop 3
v_mfma_f32_16x16x32_bf16 v[80:83], v[132:135], v[16:19], 0
v_mfma_f32_16x16x32_bf16 v[84:87], v[140:143], v[16:19], 0
s_nop 1
s_nop 1
v_cvt_pk_bf16_f32 v96, v64, v65
v_cvt_pk_bf16_f32 v97, v66, v67
v_cvt_pk_bf16_f32 v98, v68, v69
v_cvt_pk_bf16_f32 v99, v70, v71
v_mfma_f32_16x16x32_bf16 v[88:91], v[132:135], v[20:23], 0
v_mfma_f32_16x16x32_bf16 v[92:95], v[140:143], v[20:23], 0
s_nop 1
v_permlane32_swap_b32 v96, v98
v_permlane32_swap_b32 v97, v99
v_cvt_pk_bf16_f32 v100, v72, v73
v_cvt_pk_bf16_f32 v101, v74, v75
v_cvt_pk_bf16_f32 v102, v76, v77
v_cvt_pk_bf16_f32 v103, v78, v79
v_mfma_f32_16x16x32_bf16 v[64:67], v[144:147], v[16:19], 0
v_mfma_f32_16x16x32_bf16 v[68:71], v[152:155], v[16:19], 0
v_mfma_f32_16x16x16_bf16 v[32:35], v[96:97], v[112:113], 0
v_mfma_f32_16x16x16_bf16 v[40:43], v[98:99], v[112:113], 0
v_permlane32_swap_b32 v100, v102
v_permlane32_swap_b32 v101, v103
v_cvt_pk_bf16_f32 v104, v80, v81
v_cvt_pk_bf16_f32 v105, v82, v83
v_cvt_pk_bf16_f32 v106, v84, v85
v_cvt_pk_bf16_f32 v107, v86, v87
v_mfma_f32_16x16x32_bf16 v[72:75], v[144:147], v[20:23], 0
v_mfma_f32_16x16x32_bf16 v[76:79], v[152:155], v[20:23], 0
v_mfma_f32_16x16x16_bf16 v[36:39], v[100:101], v[112:113], 0
v_mfma_f32_16x16x16_bf16 v[44:47], v[102:103], v[112:113], 0
v_permlane32_swap_b32 v104, v106
v_permlane32_swap_b32 v105, v107
v_cvt_pk_bf16_f32 v108, v88, v89
v_cvt_pk_bf16_f32 v109, v90, v91
v_cvt_pk_bf16_f32 v110, v92, v93
v_cvt_pk_bf16_f32 v111, v94, v95
v_mfma_f32_16x16x32_bf16 v[80:83], v[148:151], v[16:19], 0
v_mfma_f32_16x16x32_bf16 v[84:87], v[156:159], v[16:19], 0
v_mfma_f32_16x16x16_bf16 v[48:51], v[104:105], v[112:113], 0
v_mfma_f32_16x16x16_bf16 v[56:59], v[106:107], v[112:113], 0
v_permlane32_swap_b32 v108, v110
v_permlane32_swap_b32 v109, v111
v_cvt_pk_bf16_f32 v96, v64, v65
v_cvt_pk_bf16_f32 v97, v66, v67
v_cvt_pk_bf16_f32 v98, v68, v69
v_cvt_pk_bf16_f32 v99, v70, v71
v_mfma_f32_16x16x32_bf16 v[88:91], v[148:151], v[20:23], 0
v_mfma_f32_16x16x32_bf16 v[92:95], v[156:159], v[20:23], 0
v_mfma_f32_16x16x16_bf16 v[52:55], v[108:109], v[112:113], 0
v_mfma_f32_16x16x16_bf16 v[60:63], v[110:111], v[112:113], 0
v_permlane32_swap_b32 v96, v98
v_permlane32_swap_b32 v97, v99
v_cvt_pk_bf16_f32 v100, v72, v73
v_cvt_pk_bf16_f32 v101, v74, v75
v_cvt_pk_bf16_f32 v102, v76, v77
v_cvt_pk_bf16_f32 v103, v78, v79
v_mfma_f32_16x16x32_bf16 v[64:67], v[160:163], v[16:19], 0
v_mfma_f32_16x16x32_bf16 v[68:71], v[168:171], v[16:19], 0
v_mfma_f32_16x16x16_bf16 v[32:35], v[96:97], v[114:115], v[32:35]
v_mfma_f32_16x16x16_bf16 v[40:43], v[98:99], v[114:115], v[40:43]
v_permlane32_swap_b32 v100, v102
v_permlane32_swap_b32 v101, v103
v_cvt_pk_bf16_f32 v104, v80, v81
v_cvt_pk_bf16_f32 v105, v82, v83
v_cvt_pk_bf16_f32 v106, v84, v85
v_cvt_pk_bf16_f32 v107, v86, v87
v_mfma_f32_16x16x32_bf16 v[72:75], v[160:163], v[20:23], 0
v_mfma_f32_16x16x32_bf16 v[76:79], v[168:171], v[20:23], 0
v_mfma_f32_16x16x16_bf16 v[36:39], v[100:101], v[114:115], v[36:39]
v_mfma_f32_16x16x16_bf16 v[44:47], v[102:103], v[114:115], v[44:47]
v_permlane32_swap_b32 v104, v106
v_permlane32_swap_b32 v105, v107
v_cvt_pk_bf16_f32 v108, v88, v89
v_cvt_pk_bf16_f32 v109, v90, v91
v_cvt_pk_bf16_f32 v110, v92, v93
v_cvt_pk_bf16_f32 v111, v94, v95
v_mfma_f32_16x16x32_bf16 v[80:83], v[164:167], v[16:19], 0
v_mfma_f32_16x16x32_bf16 v[84:87], v[172:175], v[16:19], 0
v_mfma_f32_16x16x16_bf16 v[48:51], v[104:105], v[114:115], v[48:51]
v_mfma_f32_16x16x16_bf16 v[56:59], v[106:107], v[114:115], v[56:59]
v_permlane32_swap_b32 v108, v110
v_permlane32_swap_b32 v109, v111
v_cvt_pk_bf16_f32 v96, v64, v65
v_cvt_pk_bf16_f32 v97, v66, v67
v_cvt_pk_bf16_f32 v98, v68, v69
v_cvt_pk_bf16_f32 v99, v70, v71
v_mfma_f32_16x16x32_bf16 v[88:91], v[164:167], v[20:23], 0
v_mfma_f32_16x16x32_bf16 v[92:95], v[172:175], v[20:23], 0
v_mfma_f32_16x16x16_bf16 v[52:55], v[108:109], v[114:115], v[52:55]
v_mfma_f32_16x16x16_bf16 v[60:63], v[110:111], v[114:115], v[60:63]
v_permlane32_swap_b32 v96, v98
v_permlane32_swap_b32 v97, v99
v_cvt_pk_bf16_f32 v100, v72, v73
v_cvt_pk_bf16_f32 v101, v74, v75
v_cvt_pk_bf16_f32 v102, v76, v77
v_cvt_pk_bf16_f32 v103, v78, v79
v_mfma_f32_16x16x32_bf16 v[64:67], v[176:179], v[16:19], 0
v_mfma_f32_16x16x32_bf16 v[68:71], v[184:187], v[16:19], 0
v_mfma_f32_16x16x16_bf16 v[32:35], v[96:97], v[116:117], v[32:35]
v_mfma_f32_16x16x16_bf16 v[40:43], v[98:99], v[116:117], v[40:43]
v_permlane32_swap_b32 v100, v102
v_permlane32_swap_b32 v101, v103
v_cvt_pk_bf16_f32 v104, v80, v81
v_cvt_pk_bf16_f32 v105, v82, v83
v_cvt_pk_bf16_f32 v106, v84, v85
v_cvt_pk_bf16_f32 v107, v86, v87
v_mfma_f32_16x16x32_bf16 v[72:75], v[176:179], v[20:23], 0
v_mfma_f32_16x16x32_bf16 v[76:79], v[184:187], v[20:23], 0
v_mfma_f32_16x16x16_bf16 v[36:39], v[100:101], v[116:117], v[36:39]
v_mfma_f32_16x16x16_bf16 v[44:47], v[102:103], v[116:117], v[44:47]
v_permlane32_swap_b32 v104, v106
v_permlane32_swap_b32 v105, v107
v_cvt_pk_bf16_f32 v108, v88, v89
v_cvt_pk_bf16_f32 v109, v90, v91
v_cvt_pk_bf16_f32 v110, v92, v93
v_cvt_pk_bf16_f32 v111, v94, v95
v_mfma_f32_16x16x32_bf16 v[80:83], v[180:183], v[16:19], 0
v_mfma_f32_16x16x32_bf16 v[84:87], v[188:191], v[16:19], 0
v_mfma_f32_16x16x16_bf16 v[48:51], v[104:105], v[116:117], v[48:51]
v_mfma_f32_16x16x16_bf16 v[56:59], v[106:107], v[116:117], v[56:59]
v_permlane32_swap_b32 v108, v110
v_permlane32_swap_b32 v109, v111
v_cvt_pk_bf16_f32 v96, v64, v65
v_cvt_pk_bf16_f32 v97, v66, v67
v_cvt_pk_bf16_f32 v98, v68, v69
v_cvt_pk_bf16_f32 v99, v70, v71
v_mfma_f32_16x16x32_bf16 v[88:91], v[180:183], v[20:23], 0
v_mfma_f32_16x16x32_bf16 v[92:95], v[188:191], v[20:23], 0
v_mfma_f32_16x16x16_bf16 v[52:55], v[108:109], v[116:117], v[52:55]
v_mfma_f32_16x16x16_bf16 v[60:63], v[110:111], v[116:117], v[60:63]
v_permlane32_swap_b32 v96, v98
v_permlane32_swap_b32 v97, v99
v_cvt_pk_bf16_f32 v100, v72, v73
v_cvt_pk_bf16_f32 v101, v74, v75
v_cvt_pk_bf16_f32 v102, v76, v77
v_cvt_pk_bf16_f32 v103, v78, v79
v_mfma_f32_16x16x32_bf16 v[64:67], v[192:195], v[16:19], 0
v_mfma_f32_16x16x32_bf16 v[68:71], v[200:203], v[16:19], 0
v_mfma_f32_16x16x16_bf16 v[32:35], v[96:97], v[118:119], v[32:35]
v_mfma_f32_16x16x16_bf16 v[40:43], v[98:99], v[118:119], v[40:43]
v_permlane32_swap_b32 v100, v102
v_permlane32_swap_b32 v101, v103
v_cvt_pk_bf16_f32 v104, v80, v81
v_cvt_pk_bf16_f32 v105, v82, v83
v_cvt_pk_bf16_f32 v106, v84, v85
v_cvt_pk_bf16_f32 v107, v86, v87
v_mfma_f32_16x16x32_bf16 v[72:75], v[192:195], v[20:23], 0
v_mfma_f32_16x16x32_bf16 v[76:79], v[200:203], v[20:23], 0
v_mfma_f32_16x16x16_bf16 v[36:39], v[100:101], v[118:119], v[36:39]
v_mfma_f32_16x16x16_bf16 v[44:47], v[102:103], v[118:119], v[44:47]
v_permlane32_swap_b32 v104, v106
v_permlane32_swap_b32 v105, v107
v_cvt_pk_bf16_f32 v108, v88, v89
v_cvt_pk_bf16_f32 v109, v90, v91
v_cvt_pk_bf16_f32 v110, v92, v93
v_cvt_pk_bf16_f32 v111, v94, v95
v_mfma_f32_16x16x32_bf16 v[80:83], v[196:199], v[16:19], 0
v_mfma_f32_16x16x32_bf16 v[84:87], v[204:207], v[16:19], 0
v_mfma_f32_16x16x16_bf16 v[48:51], v[104:105], v[118:119], v[48:51]
v_mfma_f32_16x16x16_bf16 v[56:59], v[106:107], v[118:119], v[56:59]
v_permlane32_swap_b32 v108, v110
v_permlane32_swap_b32 v109, v111
v_cvt_pk_bf16_f32 v96, v64, v65
v_cvt_pk_bf16_f32 v97, v66, v67
v_cvt_pk_bf16_f32 v98, v68, v69
v_cvt_pk_bf16_f32 v99, v70, v71
v_mfma_f32_16x16x32_bf16 v[88:91], v[196:199], v[20:23], 0
v_mfma_f32_16x16x32_bf16 v[92:95], v[204:207], v[20:23], 0
v_mfma_f32_16x16x16_bf16 v[52:55], v[108:109], v[118:119], v[52:55]
v_mfma_f32_16x16x16_bf16 v[60:63], v[110:111], v[118:119], v[60:63]
v_permlane32_swap_b32 v96, v98
v_permlane32_swap_b32 v97, v99
v_cvt_pk_bf16_f32 v100, v72, v73
v_cvt_pk_bf16_f32 v101, v74, v75
v_cvt_pk_bf16_f32 v102, v76, v77
v_cvt_pk_bf16_f32 v103, v78, v79
v_mfma_f32_16x16x32_bf16 v[64:67], v[208:211], v[16:19], 0
v_mfma_f32_16x16x32_bf16 v[68:71], v[216:219], v[16:19], 0
v_mfma_f32_16x16x16_bf16 v[32:35], v[96:97], v[120:121], v[32:35]
v_mfma_f32_16x16x16_bf16 v[40:43], v[98:99], v[120:121], v[40:43]
v_permlane32_swap_b32 v100, v102
v_permlane32_swap_b32 v101, v103
v_cvt_pk_bf16_f32 v104, v80, v81
v_cvt_pk_bf16_f32 v105, v82, v83
v_cvt_pk_bf16_f32 v106, v84, v85
v_cvt_pk_bf16_f32 v107, v86, v87
v_mfma_f32_16x16x32_bf16 v[72:75], v[208:211], v[20:23], 0
v_mfma_f32_16x16x32_bf16 v[76:79], v[216:219], v[20:23], 0
v_mfma_f32_16x16x16_bf16 v[36:39], v[100:101], v[120:121], v[36:39]
v_mfma_f32_16x16x16_bf16 v[44:47], v[102:103], v[120:121], v[44:47]
v_permlane32_swap_b32 v104, v106
v_permlane32_swap_b32 v105, v107
v_cvt_pk_bf16_f32 v108, v88, v89
v_cvt_pk_bf16_f32 v109, v90, v91
v_cvt_pk_bf16_f32 v110, v92, v93
v_cvt_pk_bf16_f32 v111, v94, v95
v_mfma_f32_16x16x32_bf16 v[80:83], v[212:215], v[16:19], 0
v_mfma_f32_16x16x32_bf16 v[84:87], v[220:223], v[16:19], 0
v_mfma_f32_16x16x16_bf16 v[48:51], v[104:105], v[120:121], v[48:51]
v_mfma_f32_16x16x16_bf16 v[56:59], v[106:107], v[120:121], v[56:59]
v_permlane32_swap_b32 v108, v110
v_permlane32_swap_b32 v109, v111
v_cvt_pk_bf16_f32 v96, v64, v65
v_cvt_pk_bf16_f32 v97, v66, v67
v_cvt_pk_bf16_f32 v98, v68, v69
v_cvt_pk_bf16_f32 v99, v70, v71
v_mfma_f32_16x16x32_bf16 v[88:91], v[212:215], v[20:23], 0
v_mfma_f32_16x16x32_bf16 v[92:95], v[220:223], v[20:23], 0
v_mfma_f32_16x16x16_bf16 v[52:55], v[108:109], v[120:121], v[52:55]
v_mfma_f32_16x16x16_bf16 v[60:63], v[110:111], v[120:121], v[60:63]
v_permlane32_swap_b32 v96, v98
v_permlane32_swap_b32 v97, v99
v_cvt_pk_bf16_f32 v100, v72, v73
v_cvt_pk_bf16_f32 v101, v74, v75
v_cvt_pk_bf16_f32 v102, v76, v77
v_cvt_pk_bf16_f32 v103, v78, v79
v_mfma_f32_16x16x32_bf16 v[64:67], v[224:227], v[16:19], 0
v_mfma_f32_16x16x32_bf16 v[68:71], v[232:235], v[16:19], 0
v_mfma_f32_16x16x16_bf16 v[32:35], v[96:97], v[122:123], v[32:35]
v_mfma_f32_16x16x16_bf16 v[40:43], v[98:99], v[122:123], v[40:43]
v_permlane32_swap_b32 v100, v102
v_permlane32_swap_b32 v101, v103
v_cvt_pk_bf16_f32 v104, v80, v81
v_cvt_pk_bf16_f32 v105, v82, v83
v_cvt_pk_bf16_f32 v106, v84, v85
v_cvt_pk_bf16_f32 v107, v86, v87
v_mfma_f32_16x16x32_bf16 v[72:75], v[224:227], v[20:23], 0
v_mfma_f32_16x16x32_bf16 v[76:79], v[232:235], v[20:23], 0
v_mfma_f32_16x16x16_bf16 v[36:39], v[100:101], v[122:123], v[36:39]
v_mfma_f32_16x16x16_bf16 v[44:47], v[102:103], v[122:123], v[44:47]
v_permlane32_swap_b32 v104, v106
v_permlane32_swap_b32 v105, v107
v_cvt_pk_bf16_f32 v108, v88, v89
v_cvt_pk_bf16_f32 v109, v90, v91
v_cvt_pk_bf16_f32 v110, v92, v93
v_cvt_pk_bf16_f32 v111, v94, v95
v_mfma_f32_16x16x32_bf16 v[80:83], v[228:231], v[16:19], 0
v_mfma_f32_16x16x32_bf16 v[84:87], v[236:239], v[16:19], 0
v_mfma_f32_16x16x16_bf16 v[48:51], v[104:105], v[122:123], v[48:51]
v_mfma_f32_16x16x16_bf16 v[56:59], v[106:107], v[122:123], v[56:59]
v_permlane32_swap_b32 v108, v110
v_permlane32_swap_b32 v109, v111
v_cvt_pk_bf16_f32 v96, v64, v65
v_cvt_pk_bf16_f32 v97, v66, v67
v_cvt_pk_bf16_f32 v98, v68, v69
v_cvt_pk_bf16_f32 v99, v70, v71
v_mfma_f32_16x16x32_bf16 v[88:91], v[228:231], v[20:23], 0
v_mfma_f32_16x16x32_bf16 v[92:95], v[236:239], v[20:23], 0
v_mfma_f32_16x16x16_bf16 v[52:55], v[108:109], v[122:123], v[52:55]
v_mfma_f32_16x16x16_bf16 v[60:63], v[110:111], v[122:123], v[60:63]
v_permlane32_swap_b32 v96, v98
v_permlane32_swap_b32 v97, v99
v_cvt_pk_bf16_f32 v100, v72, v73
v_cvt_pk_bf16_f32 v101, v74, v75
v_cvt_pk_bf16_f32 v102, v76, v77
v_cvt_pk_bf16_f32 v103, v78, v79
v_mfma_f32_16x16x32_bf16 v[64:67], v[240:243], v[16:19], 0
v_mfma_f32_16x16x32_bf16 v[68:71], v[248:251], v[16:19], 0
v_mfma_f32_16x16x16_bf16 v[32:35], v[96:97], v[124:125], v[32:35]
v_mfma_f32_16x16x16_bf16 v[40:43], v[98:99], v[124:125], v[40:43]
v_permlane32_swap_b32 v100, v102
v_permlane32_swap_b32 v101, v103
v_cvt_pk_bf16_f32 v104, v80, v81
v_cvt_pk_bf16_f32 v105, v82, v83
v_cvt_pk_bf16_f32 v106, v84, v85
v_cvt_pk_bf16_f32 v107, v86, v87
v_mfma_f32_16x16x32_bf16 v[72:75], v[240:243], v[20:23], 0
v_mfma_f32_16x16x32_bf16 v[76:79], v[248:251], v[20:23], 0
v_mfma_f32_16x16x16_bf16 v[36:39], v[100:101], v[124:125], v[36:39]
v_mfma_f32_16x16x16_bf16 v[44:47], v[102:103], v[124:125], v[44:47]
v_permlane32_swap_b32 v104, v106
v_permlane32_swap_b32 v105, v107
v_cvt_pk_bf16_f32 v108, v88, v89
v_cvt_pk_bf16_f32 v109, v90, v91
v_cvt_pk_bf16_f32 v110, v92, v93
v_cvt_pk_bf16_f32 v111, v94, v95
v_mfma_f32_16x16x32_bf16 v[80:83], v[244:247], v[16:19], 0
v_mfma_f32_16x16x32_bf16 v[84:87], v[252:255], v[16:19], 0
v_mfma_f32_16x16x16_bf16 v[48:51], v[104:105], v[124:125], v[48:51]
v_mfma_f32_16x16x16_bf16 v[56:59], v[106:107], v[124:125], v[56:59]
v_permlane32_swap_b32 v108, v110
v_permlane32_swap_b32 v109, v111
v_cvt_pk_bf16_f32 v96, v64, v65
v_cvt_pk_bf16_f32 v97, v66, v67
v_cvt_pk_bf16_f32 v98, v68, v69
v_cvt_pk_bf16_f32 v99, v70, v71
v_mfma_f32_16x16x32_bf16 v[88:91], v[244:247], v[20:23], 0
v_mfma_f32_16x16x32_bf16 v[92:95], v[252:255], v[20:23], 0
v_mfma_f32_16x16x16_bf16 v[52:55], v[108:109], v[124:125], v[52:55]
v_mfma_f32_16x16x16_bf16 v[60:63], v[110:111], v[124:125], v[60:63]
v_permlane32_swap_b32 v96, v98
v_permlane32_swap_b32 v97, v99
v_cvt_pk_bf16_f32 v100, v72, v73
v_cvt_pk_bf16_f32 v101, v74, v75
v_cvt_pk_bf16_f32 v102, v76, v77
v_cvt_pk_bf16_f32 v103, v78, v79
s_nop 1
v_mfma_f32_16x16x16_bf16 v[32:35], v[96:97], v[126:127], v[32:35]
v_mfma_f32_16x16x16_bf16 v[40:43], v[98:99], v[126:127], v[40:43]
v_permlane32_swap_b32 v100, v102
v_permlane32_swap_b32 v101, v103
v_cvt_pk_bf16_f32 v104, v80, v81
v_cvt_pk_bf16_f32 v105, v82, v83
v_cvt_pk_bf16_f32 v106, v84, v85
v_cvt_pk_bf16_f32 v107, v86, v87
s_nop 1
v_mfma_f32_16x16x16_bf16 v[36:39], v[100:101], v[126:127], v[36:39]
v_mfma_f32_16x16x16_bf16 v[44:47], v[102:103], v[126:127], v[44:47]
v_permlane32_swap_b32 v104, v106
v_permlane32_swap_b32 v105, v107
v_cvt_pk_bf16_f32 v108, v88, v89
v_cvt_pk_bf16_f32 v109, v90, v91
v_cvt_pk_bf16_f32 v110, v92, v93
v_cvt_pk_bf16_f32 v111, v94, v95
s_nop 1
v_mfma_f32_16x16x16_bf16 v[48:51], v[104:105], v[126:127], v[48:51]
v_mfma_f32_16x16x16_bf16 v[56:59], v[106:107], v[126:127], v[56:59]
v_permlane32_swap_b32 v108, v110
v_permlane32_swap_b32 v109, v111
s_nop 3
s_nop 1
v_mfma_f32_16x16x16_bf16 v[52:55], v[108:109], v[126:127], v[52:55]
v_mfma_f32_16x16x16_bf16 v[60:63], v[110:111], v[126:127], v[60:63]
s_nop 1
s_nop 3
s_nop 7
s_nop 7
v_cvt_pk_bf16_f32 v64, v32, v33
v_cvt_pk_bf16_f32 v65, v34, v35
v_cvt_pk_bf16_f32 v66, v36, v37
v_cvt_pk_bf16_f32 v67, v38, v39
v_cvt_pk_bf16_f32 v68, v40, v41
v_cvt_pk_bf16_f32 v69, v42, v43
v_cvt_pk_bf16_f32 v70, v44, v45
v_cvt_pk_bf16_f32 v71, v46, v47
v_cvt_pk_bf16_f32 v72, v48, v49
v_cvt_pk_bf16_f32 v73, v50, v51
v_cvt_pk_bf16_f32 v74, v52, v53
v_cvt_pk_bf16_f32 v75, v54, v55
v_cvt_pk_bf16_f32 v76, v56, v57
v_cvt_pk_bf16_f32 v77, v58, v59
v_cvt_pk_bf16_f32 v78, v60, v61
v_cvt_pk_bf16_f32 v79, v62, v63
v_lshlrev_b32 v8, 6, v14
v_and_b32 v9, 1, v3
v_lshl_add_u32 v8, v9, 5, v8
v_lshrrev_b32 v9, 1, v3
v_lshl_add_u32 v8, v9, 4, v8
v_permlane16_swap_b32 v64, v66
v_permlane16_swap_b32 v65, v67
v_permlane16_swap_b32 v68, v70
v_permlane16_swap_b32 v69, v71
v_permlane16_swap_b32 v72, v74
v_permlane16_swap_b32 v73, v75
v_permlane16_swap_b32 v76, v78
v_permlane16_swap_b32 v77, v79
s_lshl_b32 s10, s9, 15
s_lshl_b32 s11, s3, 12
s_add_u32 s10, s10, s11
s_add_u32 s10, s10, 1048576
buffer_store_dwordx4 v[64:67], v8, s[56:59], s10 offen offset:0 sc1
buffer_store_dwordx4 v[68:71], v8, s[56:59], s10 offen offset:1024 sc1
buffer_store_dwordx4 v[72:75], v8, s[56:59], s10 offen offset:2048 sc1
buffer_store_dwordx4 v[76:79], v8, s[56:59], s10 offen offset:3072 sc1
s_waitcnt vmcnt(0)
s_barrier
s_cmp_lg_u32 s3, 0
s_cbranch_scc1 L_sg_p
v_mov_b32 v10, s94
v_mov_b32 v11, s95
s_lshl_b32 s10, s9, 7
s_add_u32 s10, s10, 0xe6000
v_mov_b32 v9, 0
s_mov_b64 exec, 1
buffer_store_dwordx2 v[10:11], v9, s[56:59], s10 offen sc1
s_mov_b64 exec, -1
L_sg_p:
s_lshl_b32 s11, s3, 13
s_mov_b32 m0, s11
s_waitcnt vmcnt(7)
buffer_load_dwordx4 v4, s[48:51], s97 offen nt lds
s_add_u32 s97, s97, 0x4000
s_add_u32 s11, s11, 0x400
s_mov_b32 m0, s11
s_waitcnt vmcnt(7)
buffer_load_dwordx4 v4, s[48:51], s97 offen nt lds
s_add_u32 s97, s97, 0x4000
s_add_u32 s11, s11, 0x400
s_mov_b32 m0, s11
s_waitcnt vmcnt(7)
buffer_load_dwordx4 v4, s[48:51], s97 offen nt lds
s_add_u32 s97, s97, 0x4000
s_add_u32 s11, s11, 0x400
s_mov_b32 m0, s11
s_waitcnt vmcnt(7)
buffer_load_dwordx4 v4, s[48:51], s97 offen nt lds
s_add_u32 s97, s97, 0x4000
s_add_u32 s11, s11, 0x400
s_mov_b32 m0, s11
s_waitcnt vmcnt(7)
buffer_load_dwordx4 v4, s[48:51], s97 offen nt lds
s_add_u32 s97, s97, 0x4000
s_add_u32 s11, s11, 0x400
s_mov_b32 m0, s11
s_waitcnt vmcnt(7)
buffer_load_dwordx4 v4, s[48:51], s97 offen nt lds
s_add_u32 s97, s97, 0x4000
s_add_u32 s11, s11, 0x400
s_mov_b32 m0, s11
s_waitcnt vmcnt(7)
buffer_load_dwordx4 v4, s[48:51], s97 offen nt lds
s_add_u32 s97, s97, 0x4000
s_add_u32 s11, s11, 0x400
s_mov_b32 m0, s11
s_waitcnt vmcnt(7)
buffer_load_dwordx4 v4, s[48:51], s97 offen nt lds
s_cmp_lg_u32 s3, 0
s_cbranch_scc1 L_pw_p
v_lshlrev_b32 v9, 7, v1
s_mov_b32 s10, 0xe6000
s_mov_b32 s11, 0
L_pl_p:
buffer_load_dwordx2 v[10:11], v9, s[56:59], s10 offen sc1
s_waitcnt vmcnt(0)
v_cmp_ne_u64 vcc, s[94:95], v[10:11]
s_cmp_eq_u64 vcc, 0
s_cbranch_scc1 L_pd_p
s_sleep 24
s_add_u32 s11, s11, 1
s_cmp_lt_u32 s11, 0x40000
s_cbranch_scc1 L_pl_p
L_pd_p:
s_mov_b64 exec, -1
L_pw_p:
s_barrier
v_lshlrev_b32 v8, 7, v1
s_lshl_b32 s10, s4, 3
s_add_u32 s10, s10, 393216
buffer_load_dwordx2 v[12:13], v8, s[56:59], s10 offen sc1
v_lshrrev_b32 v10, 2, v1
v_lshlrev_b32 v8, 15, v10
v_and_b32 v9, 3, v1
v_lshl_add_u32 v8, v9, 4, v8
s_lshl_b32 s10, s14, 3
s_add_u32 s10, s10, s3
s_lshl_b32 s10, s10, 10
s_lshl_b32 s11, s4, 6
s_add_u32 s10, s10, s11
s_add_u32 s10, s10, 1048576
buffer_load_dwordx4 v[32:35], v8, s[56:59], s10 offen sc1
s_add_u32 s10, s10, 0x80000
buffer_load_dwordx4 v[36:39], v8, s[56:59], s10 offen sc1
s_add_u32 s10, s10, 0x80000
buffer_load_dwordx4 v[40:43], v8, s[56:59], s10 offen sc1
s_add_u32 s10, s10, 0x80000
buffer_load_dwordx4 v[44:47], v8, s[56:59], s10 offen sc1
s_waitcnt vmcnt(4)
v_mov_b32 v14, v12
s_nop 1
v_max_f32_dpp v14, v14, v14 row_ror:1 row_mask:0xf bank_mask:0xf
s_nop 1
v_max_f32_dpp v14, v14, v14 row_ror:2 row_mask:0xf bank_mask:0xf
s_nop 1
v_max_f32_dpp v14, v14, v14 row_ror:4 row_mask:0xf bank_mask:0xf
s_nop 1
v_max_f32_dpp v14, v14, v14 row_ror:8 row_mask:0xf bank_mask:0xf
v_mov_b32 v8, v14
s_nop 1
v_permlane16_swap_b32 v14, v8
s_nop 1
v_max_f32 v14, v14, v8
v_sub_f32 v12, v12, v14
v_mul_f32 v12, s15, v12
v_exp_f32 v12, v12
s_nop 0
v_mul_f32 v13, v12, v13
s_nop 1
v_add_f32_dpp v13, v13, v13 row_ror:1 row_mask:0xf bank_mask:0xf
s_nop 1
v_add_f32_dpp v13, v13, v13 row_ror:2 row_mask:0xf bank_mask:0xf
s_nop 1
v_add_f32_dpp v13, v13, v13 row_ror:4 row_mask:0xf bank_mask:0xf
s_nop 1
v_add_f32_dpp v13, v13, v13 row_ror:8 row_mask:0xf bank_mask:0xf
v_mov_b32 v8, v13
s_nop 1
v_permlane16_swap_b32 v13, v8
s_nop 1
v_add_f32 v13, v13, v8
v_rcp_f32 v14, v13
s_nop 0
v_fma_f32 v15, -v13, v14, 1.0
v_fmac_f32 v14, v15, v14
v_mul_f32 v12, v12, v14
v_lshlrev_b32 v10, 2, v10
v_add_u32 v8, 0, v10
ds_bpermute_b32 v64, v8, v12
v_add_u32 v8, 64, v10
ds_bpermute_b32 v65, v8, v12
v_add_u32 v8, 128, v10
ds_bpermute_b32 v66, v8, v12
v_add_u32 v8, 192, v10
ds_bpermute_b32 v67, v8, v12
s_waitcnt vmcnt(0) lgkmcnt(0)
s_lshl_b32 s11, s3, 13
v_lshlrev_b32 v11, 4, v1
v_add_u32 v11, s11, v11
v_add_u32 v15, 0x10000, v11
ds_read_b128 v[128:131], v15 offset:0
ds_read_b128 v[132:135], v15 offset:1024
ds_read_b128 v[136:139], v15 offset:2048
ds_read_b128 v[140:143], v15 offset:3072
ds_read_b128 v[144:147], v15 offset:4096
ds_read_b128 v[148:151], v15 offset:5120
ds_read_b128 v[152:155], v15 offset:6144
ds_read_b128 v[156:159], v15 offset:7168
ds_read_b128 v[160:163], v11 offset:0
ds_read_b128 v[164:167], v11 offset:1024
ds_read_b128 v[168:171], v11 offset:2048
ds_read_b128 v[172:175], v11 offset:3072
ds_read_b128 v[176:179], v11 offset:4096
ds_read_b128 v[180:183], v11 offset:5120
ds_read_b128 v[184:187], v11 offset:6144
ds_read_b128 v[188:191], v11 offset:7168
v_lshlrev_b32 v8, 16, v32
v_and_b32 v14, 0xffff0000, v32
v_mul_f32 v72, v64, v8
v_mul_f32 v73, v64, v14
v_lshlrev_b32 v8, 16, v33
v_and_b32 v14, 0xffff0000, v33
v_mul_f32 v74, v64, v8
v_mul_f32 v75, v64, v14
v_lshlrev_b32 v8, 16, v34
v_and_b32 v14, 0xffff0000, v34
v_mul_f32 v76, v64, v8
v_mul_f32 v77, v64, v14
v_lshlrev_b32 v8, 16, v35
v_and_b32 v14, 0xffff0000, v35
v_mul_f32 v78, v64, v8
v_mul_f32 v79, v64, v14
v_lshlrev_b32 v8, 16, v36
v_and_b32 v14, 0xffff0000, v36
v_fmac_f32 v72, v65, v8
v_fmac_f32 v73, v65, v14
v_lshlrev_b32 v8, 16, v37
v_and_b32 v14, 0xffff0000, v37
v_fmac_f32 v74, v65, v8
v_fmac_f32 v75, v65, v14
v_lshlrev_b32 v8, 16, v38
v_and_b32 v14, 0xffff0000, v38
v_fmac_f32 v76, v65, v8
v_fmac_f32 v77, v65, v14
v_lshlrev_b32 v8, 16, v39
v_and_b32 v14, 0xffff0000, v39
v_fmac_f32 v78, v65, v8
v_fmac_f32 v79, v65, v14
v_lshlrev_b32 v8, 16, v40
v_and_b32 v14, 0xffff0000, v40
v_mul_f32 v80, v66, v8
v_mul_f32 v81, v66, v14
v_lshlrev_b32 v8, 16, v41
v_and_b32 v14, 0xffff0000, v41
v_mul_f32 v82, v66, v8
v_mul_f32 v83, v66, v14
v_lshlrev_b32 v8, 16, v42
v_and_b32 v14, 0xffff0000, v42
v_mul_f32 v84, v66, v8
v_mul_f32 v85, v66, v14
v_lshlrev_b32 v8, 16, v43
v_and_b32 v14, 0xffff0000, v43
v_mul_f32 v86, v66, v8
v_mul_f32 v87, v66, v14
v_lshlrev_b32 v8, 16, v44
v_and_b32 v14, 0xffff0000, v44
v_fmac_f32 v80, v67, v8
v_fmac_f32 v81, v67, v14
v_lshlrev_b32 v8, 16, v45
v_and_b32 v14, 0xffff0000, v45
v_fmac_f32 v82, v67, v8
v_fmac_f32 v83, v67, v14
v_lshlrev_b32 v8, 16, v46
v_and_b32 v14, 0xffff0000, v46
v_fmac_f32 v84, v67, v8
v_fmac_f32 v85, v67, v14
v_lshlrev_b32 v8, 16, v47
v_and_b32 v14, 0xffff0000, v47
v_fmac_f32 v86, v67, v8
v_fmac_f32 v87, v67, v14
s_nop 1
v_add_f32_dpp v72, v72, v72 row_ror:4 row_mask:0xf bank_mask:0xf
v_add_f32_dpp v73, v73, v73 row_ror:4 row_mask:0xf bank_mask:0xf
v_add_f32_dpp v74, v74, v74 row_ror:4 row_mask:0xf bank_mask:0xf
v_add_f32_dpp v75, v75, v75 row_ror:4 row_mask:0xf bank_mask:0xf
v_add_f32_dpp v76, v76, v76 row_ror:4 row_mask:0xf bank_mask:0xf
v_add_f32_dpp v77, v77, v77 row_ror:4 row_mask:0xf bank_mask:0xf
v_add_f32_dpp v78, v78, v78 row_ror:4 row_mask:0xf bank_mask:0xf
v_add_f32_dpp v79, v79, v79 row_ror:4 row_mask:0xf bank_mask:0xf
v_add_f32_dpp v80, v80, v80 row_ror:4 row_mask:0xf bank_mask:0xf
v_add_f32_dpp v81, v81, v81 row_ror:4 row_mask:0xf bank_mask:0xf
v_add_f32_dpp v82, v82, v82 row_ror:4 row_mask:0xf bank_mask:0xf
v_add_f32_dpp v83, v83, v83 row_ror:4 row_mask:0xf bank_mask:0xf
v_add_f32_dpp v84, v84, v84 row_ror:4 row_mask:0xf bank_mask:0xf
v_add_f32_dpp v85, v85, v85 row_ror:4 row_mask:0xf bank_mask:0xf
v_add_f32_dpp v86, v86, v86 row_ror:4 row_mask:0xf bank_mask:0xf
v_add_f32_dpp v87, v87, v87 row_ror:4 row_mask:0xf bank_mask:0xf
v_add_f32_dpp v72, v72, v72 row_ror:8 row_mask:0xf bank_mask:0xf
v_add_f32_dpp v73, v73, v73 row_ror:8 row_mask:0xf bank_mask:0xf
v_add_f32_dpp v74, v74, v74 row_ror:8 row_mask:0xf bank_mask:0xf
v_add_f32_dpp v75, v75, v75 row_ror:8 row_mask:0xf bank_mask:0xf
v_add_f32_dpp v76, v76, v76 row_ror:8 row_mask:0xf bank_mask:0xf
v_add_f32_dpp v77, v77, v77 row_ror:8 row_mask:0xf bank_mask:0xf
v_add_f32_dpp v78, v78, v78 row_ror:8 row_mask:0xf bank_mask:0xf
v_add_f32_dpp v79, v79, v79 row_ror:8 row_mask:0xf bank_mask:0xf
v_add_f32_dpp v80, v80, v80 row_ror:8 row_mask:0xf bank_mask:0xf
v_add_f32_dpp v81, v81, v81 row_ror:8 row_mask:0xf bank_mask:0xf
v_add_f32_dpp v82, v82, v82 row_ror:8 row_mask:0xf bank_mask:0xf
v_add_f32_dpp v83, v83, v83 row_ror:8 row_mask:0xf bank_mask:0xf
v_add_f32_dpp v84, v84, v84 row_ror:8 row_mask:0xf bank_mask:0xf
v_add_f32_dpp v85, v85, v85 row_ror:8 row_mask:0xf bank_mask:0xf
v_add_f32_dpp v86, v86, v86 row_ror:8 row_mask:0xf bank_mask:0xf
v_add_f32_dpp v87, v87, v87 row_ror:8 row_mask:0xf bank_mask:0xf
v_mov_b32 v88, v72
v_mov_b32 v89, v73
v_mov_b32 v90, v74
v_mov_b32 v91, v75
v_mov_b32 v92, v76
v_mov_b32 v93, v77
v_mov_b32 v94, v78
v_mov_b32 v95, v79
v_mov_b32 v96, v80
v_mov_b32 v97, v81
v_mov_b32 v98, v82
v_mov_b32 v99, v83
v_mov_b32 v100, v84
v_mov_b32 v101, v85
v_mov_b32 v102, v86
v_mov_b32 v103, v87
s_nop 1
v_permlane16_swap_b32 v72, v88
v_permlane16_swap_b32 v73, v89
v_permlane16_swap_b32 v74, v90
v_permlane16_swap_b32 v75, v91
v_permlane16_swap_b32 v76, v92
v_permlane16_swap_b32 v77, v93
v_permlane16_swap_b32 v78, v94
v_permlane16_swap_b32 v79, v95
v_permlane16_swap_b32 v80, v96
v_permlane16_swap_b32 v81, v97
v_permlane16_swap_b32 v82, v98
v_permlane16_swap_b32 v83, v99
v_permlane16_swap_b32 v84, v100
v_permlane16_swap_b32 v85, v101
v_permlane16_swap_b32 v86, v102
v_permlane16_swap_b32 v87, v103
s_nop 1
v_add_f32 v72, v72, v88
v_add_f32 v73, v73, v89
v_add_f32 v74, v74, v90
v_add_f32 v75, v75, v91
v_add_f32 v76, v76, v92
v_add_f32 v77, v77, v93
v_add_f32 v78, v78, v94
v_add_f32 v79, v79, v95
v_add_f32 v80, v80, v96
v_add_f32 v81, v81, v97
v_add_f32 v82, v82, v98
v_add_f32 v83, v83, v99
v_add_f32 v84, v84, v100
v_add_f32 v85, v85, v101
v_add_f32 v86, v86, v102
v_add_f32 v87, v87, v103
v_mov_b32 v88, v72
v_mov_b32 v89, v73
v_mov_b32 v90, v74
v_mov_b32 v91, v75
v_mov_b32 v92, v76
v_mov_b32 v93, v77
v_mov_b32 v94, v78
v_mov_b32 v95, v79
v_mov_b32 v96, v80
v_mov_b32 v97, v81
v_mov_b32 v98, v82
v_mov_b32 v99, v83
v_mov_b32 v100, v84
v_mov_b32 v101, v85
v_mov_b32 v102, v86
v_mov_b32 v103, v87
s_nop 1
v_permlane32_swap_b32 v72, v88
v_permlane32_swap_b32 v73, v89
v_permlane32_swap_b32 v74, v90
v_permlane32_swap_b32 v75, v91
v_permlane32_swap_b32 v76, v92
v_permlane32_swap_b32 v77, v93
v_permlane32_swap_b32 v78, v94
v_permlane32_swap_b32 v79, v95
v_permlane32_swap_b32 v80, v96
v_permlane32_swap_b32 v81, v97
v_permlane32_swap_b32 v82, v98
v_permlane32_swap_b32 v83, v99
v_permlane32_swap_b32 v84, v100
v_permlane32_swap_b32 v85, v101
v_permlane32_swap_b32 v86, v102
v_permlane32_swap_b32 v87, v103
s_nop 1
v_add_f32 v72, v72, v88
v_add_f32 v73, v73, v89
v_add_f32 v74, v74, v90
v_add_f32 v75, v75, v91
v_add_f32 v76, v76, v92
v_add_f32 v77, v77, v93
v_add_f32 v78, v78, v94
v_add_f32 v79, v79, v95
v_add_f32 v80, v80, v96
v_add_f32 v81, v81, v97
v_add_f32 v82, v82, v98
v_add_f32 v83, v83, v99
v_add_f32 v84, v84, v100
v_add_f32 v85, v85, v101
v_add_f32 v86, v86, v102
v_add_f32 v87, v87, v103
s_lshl_b32 s10, s3, 8
s_add_u32 s10, s10, 139264
v_lshlrev_b32 v8, 5, v9
v_add_u32 v8, s10, v8
s_mov_b64 exec, 0xf
ds_write_b128 v8, v[72:75] offset:0
ds_write_b128 v8, v[76:79] offset:16
ds_write_b128 v8, v[80:83] offset:128
ds_write_b128 v8, v[84:87] offset:144
s_mov_b64 exec, -1
v_lshlrev_b32 v8, 2, v7
v_add_u32 v8, s10, v8
s_waitcnt lgkmcnt(0)
ds_read_b32 v32, v8 offset:0
ds_read_b32 v33, v8 offset:8
ds_read_b32 v34, v8 offset:16
ds_read_b32 v35, v8 offset:24
ds_read_b32 v36, v8 offset:32
ds_read_b32 v37, v8 offset:40
ds_read_b32 v38, v8 offset:48
ds_read_b32 v39, v8 offset:56
ds_read_b32 v40, v8 offset:64
ds_read_b32 v41, v8 offset:72
ds_read_b32 v42, v8 offset:80
ds_read_b32 v43, v8 offset:88
ds_read_b32 v44, v8 offset:96
ds_read_b32 v45, v8 offset:104
ds_read_b32 v46, v8 offset:112
ds_read_b32 v47, v8 offset:120
ds_read_b32 v48, v8 offset:128
ds_read_b32 v49, v8 offset:136
ds_read_b32 v50, v8 offset:144
ds_read_b32 v51, v8 offset:152
ds_read_b32 v52, v8 offset:160
ds_read_b32 v53, v8 offset:168
ds_read_b32 v54, v8 offset:176
ds_read_b32 v55, v8 offset:184
ds_read_b32 v56, v8 offset:192
ds_read_b32 v57, v8 offset:200
ds_read_b32 v58, v8 offset:208
ds_read_b32 v59, v8 offset:216
ds_read_b32 v60, v8 offset:224
ds_read_b32 v61, v8 offset:232
ds_read_b32 v62, v8 offset:240
ds_read_b32 v63, v8 offset:248
v_mov_b32 v96, 0
v_mov_b32 v97, 0
v_mov_b32 v98, 0
v_mov_b32 v99, 0
v_mov_b32 v100, 0
v_mov_b32 v101, 0
v_mov_b32 v102, 0
v_mov_b32 v103, 0
v_mov_b32 v104, 0
v_mov_b32 v105, 0
v_mov_b32 v106, 0
v_mov_b32 v107, 0
v_mov_b32 v108, 0
v_mov_b32 v109, 0
v_mov_b32 v110, 0
v_mov_b32 v111, 0
s_waitcnt lgkmcnt(0)
v_lshlrev_b32 v8, 16, v128
v_and_b32 v9, 0xffff0000, v128
v_fmac_f32 v96, v8, v32
v_fmac_f32 v97, v9, v32
v_fmac_f32 v104, v8, v48
v_fmac_f32 v105, v9, v48
v_lshlrev_b32 v8, 16, v129
v_and_b32 v9, 0xffff0000, v129
v_fmac_f32 v98, v8, v32
v_fmac_f32 v99, v9, v32
v_fmac_f32 v106, v8, v48
v_fmac_f32 v107, v9, v48
v_lshlrev_b32 v8, 16, v130
v_and_b32 v9, 0xffff0000, v130
v_fmac_f32 v100, v8, v32
v_fmac_f32 v101, v9, v32
v_fmac_f32 v108, v8, v48
v_fmac_f32 v109, v9, v48
v_lshlrev_b32 v8, 16, v131
v_and_b32 v9, 0xffff0000, v131
v_fmac_f32 v102, v8, v32
v_fmac_f32 v103, v9, v32
v_fmac_f32 v110, v8, v48
v_fmac_f32 v111, v9, v48
v_lshlrev_b32 v8, 16, v132
v_and_b32 v9, 0xffff0000, v132
v_fmac_f32 v96, v8, v33
v_fmac_f32 v97, v9, v33
v_fmac_f32 v104, v8, v49
v_fmac_f32 v105, v9, v49
v_lshlrev_b32 v8, 16, v133
v_and_b32 v9, 0xffff0000, v133
v_fmac_f32 v98, v8, v33
v_fmac_f32 v99, v9, v33
v_fmac_f32 v106, v8, v49
v_fmac_f32 v107, v9, v49
v_lshlrev_b32 v8, 16, v134
v_and_b32 v9, 0xffff0000, v134
v_fmac_f32 v100, v8, v33
v_fmac_f32 v101, v9, v33
v_fmac_f32 v108, v8, v49
v_fmac_f32 v109, v9, v49
v_lshlrev_b32 v8, 16, v135
v_and_b32 v9, 0xffff0000, v135
v_fmac_f32 v102, v8, v33
v_fmac_f32 v103, v9, v33
v_fmac_f32 v110, v8, v49
v_fmac_f32 v111, v9, v49
v_lshlrev_b32 v8, 16, v136
v_and_b32 v9, 0xffff0000, v136
v_fmac_f32 v96, v8, v34
v_fmac_f32 v97, v9, v34
v_fmac_f32 v104, v8, v50
v_fmac_f32 v105, v9, v50
v_lshlrev_b32 v8, 16, v137
v_and_b32 v9, 0xffff0000, v137
v_fmac_f32 v98, v8, v34
v_fmac_f32 v99, v9, v34
v_fmac_f32 v106, v8, v50
v_fmac_f32 v107, v9, v50
v_lshlrev_b32 v8, 16, v138
v_and_b32 v9, 0xffff0000, v138
v_fmac_f32 v100, v8, v34
v_fmac_f32 v101, v9, v34
v_fmac_f32 v108, v8, v50
v_fmac_f32 v109, v9, v50
v_lshlrev_b32 v8, 16, v139
v_and_b32 v9, 0xffff0000, v139
v_fmac_f32 v102, v8, v34
v_fmac_f32 v103, v9, v34
v_fmac_f32 v110, v8, v50
v_fmac_f32 v111, v9, v50
v_lshlrev_b32 v8, 16, v140
v_and_b32 v9, 0xffff0000, v140
v_fmac_f32 v96, v8, v35
v_fmac_f32 v97, v9, v35
v_fmac_f32 v104, v8, v51
v_fmac_f32 v105, v9, v51
v_lshlrev_b32 v8, 16, v141
v_and_b32 v9, 0xffff0000, v141
v_fmac_f32 v98, v8, v35
v_fmac_f32 v99, v9, v35
v_fmac_f32 v106, v8, v51
v_fmac_f32 v107, v9, v51
v_lshlrev_b32 v8, 16, v142
v_and_b32 v9, 0xffff0000, v142
v_fmac_f32 v100, v8, v35
v_fmac_f32 v101, v9, v35
v_fmac_f32 v108, v8, v51
v_fmac_f32 v109, v9, v51
v_lshlrev_b32 v8, 16, v143
v_and_b32 v9, 0xffff0000, v143
v_fmac_f32 v102, v8, v35
v_fmac_f32 v103, v9, v35
v_fmac_f32 v110, v8, v51
v_fmac_f32 v111, v9, v51
v_lshlrev_b32 v8, 16, v144
v_and_b32 v9, 0xffff0000, v144
v_fmac_f32 v96, v8, v36
v_fmac_f32 v97, v9, v36
v_fmac_f32 v104, v8, v52
v_fmac_f32 v105, v9, v52
v_lshlrev_b32 v8, 16, v145
v_and_b32 v9, 0xffff0000, v145
v_fmac_f32 v98, v8, v36
v_fmac_f32 v99, v9, v36
v_fmac_f32 v106, v8, v52
v_fmac_f32 v107, v9, v52
v_lshlrev_b32 v8, 16, v146
v_and_b32 v9, 0xffff0000, v146
v_fmac_f32 v100, v8, v36
v_fmac_f32 v101, v9, v36
v_fmac_f32 v108, v8, v52
v_fmac_f32 v109, v9, v52
v_lshlrev_b32 v8, 16, v147
v_and_b32 v9, 0xffff0000, v147
v_fmac_f32 v102, v8, v36
v_fmac_f32 v103, v9, v36
v_fmac_f32 v110, v8, v52
v_fmac_f32 v111, v9, v52
v_lshlrev_b32 v8, 16, v148
v_and_b32 v9, 0xffff0000, v148
v_fmac_f32 v96, v8, v37
v_fmac_f32 v97, v9, v37
v_fmac_f32 v104, v8, v53
v_fmac_f32 v105, v9, v53
v_lshlrev_b32 v8, 16, v149
v_and_b32 v9, 0xffff0000, v149
v_fmac_f32 v98, v8, v37
v_fmac_f32 v99, v9, v37
v_fmac_f32 v106, v8, v53
v_fmac_f32 v107, v9, v53
v_lshlrev_b32 v8, 16, v150
v_and_b32 v9, 0xffff0000, v150
v_fmac_f32 v100, v8, v37
v_fmac_f32 v101, v9, v37
v_fmac_f32 v108, v8, v53
v_fmac_f32 v109, v9, v53
v_lshlrev_b32 v8, 16, v151
v_and_b32 v9, 0xffff0000, v151
v_fmac_f32 v102, v8, v37
v_fmac_f32 v103, v9, v37
v_fmac_f32 v110, v8, v53
v_fmac_f32 v111, v9, v53
v_lshlrev_b32 v8, 16, v152
v_and_b32 v9, 0xffff0000, v152
v_fmac_f32 v96, v8, v38
v_fmac_f32 v97, v9, v38
v_fmac_f32 v104, v8, v54
v_fmac_f32 v105, v9, v54
v_lshlrev_b32 v8, 16, v153
v_and_b32 v9, 0xffff0000, v153
v_fmac_f32 v98, v8, v38
v_fmac_f32 v99, v9, v38
v_fmac_f32 v106, v8, v54
v_fmac_f32 v107, v9, v54
v_lshlrev_b32 v8, 16, v154
v_and_b32 v9, 0xffff0000, v154
v_fmac_f32 v100, v8, v38
v_fmac_f32 v101, v9, v38
v_fmac_f32 v108, v8, v54
v_fmac_f32 v109, v9, v54
v_lshlrev_b32 v8, 16, v155
v_and_b32 v9, 0xffff0000, v155
v_fmac_f32 v102, v8, v38
v_fmac_f32 v103, v9, v38
v_fmac_f32 v110, v8, v54
v_fmac_f32 v111, v9, v54
v_lshlrev_b32 v8, 16, v156
v_and_b32 v9, 0xffff0000, v156
v_fmac_f32 v96, v8, v39
v_fmac_f32 v97, v9, v39
v_fmac_f32 v104, v8, v55
v_fmac_f32 v105, v9, v55
v_lshlrev_b32 v8, 16, v157
v_and_b32 v9, 0xffff0000, v157
v_fmac_f32 v98, v8, v39
v_fmac_f32 v99, v9, v39
v_fmac_f32 v106, v8, v55
v_fmac_f32 v107, v9, v55
v_lshlrev_b32 v8, 16, v158
v_and_b32 v9, 0xffff0000, v158
v_fmac_f32 v100, v8, v39
v_fmac_f32 v101, v9, v39
v_fmac_f32 v108, v8, v55
v_fmac_f32 v109, v9, v55
v_lshlrev_b32 v8, 16, v159
v_and_b32 v9, 0xffff0000, v159
v_fmac_f32 v102, v8, v39
v_fmac_f32 v103, v9, v39
v_fmac_f32 v110, v8, v55
v_fmac_f32 v111, v9, v55
v_lshlrev_b32 v8, 16, v160
v_and_b32 v9, 0xffff0000, v160
v_fmac_f32 v96, v8, v40
v_fmac_f32 v97, v9, v40
v_fmac_f32 v104, v8, v56
v_fmac_f32 v105, v9, v56
v_lshlrev_b32 v8, 16, v161
v_and_b32 v9, 0xffff0000, v161
v_fmac_f32 v98, v8, v40
v_fmac_f32 v99, v9, v40
v_fmac_f32 v106, v8, v56
v_fmac_f32 v107, v9, v56
v_lshlrev_b32 v8, 16, v162
v_and_b32 v9, 0xffff0000, v162
v_fmac_f32 v100, v8, v40
v_fmac_f32 v101, v9, v40
v_fmac_f32 v108, v8, v56
v_fmac_f32 v109, v9, v56
v_lshlrev_b32 v8, 16, v163
v_and_b32 v9, 0xffff0000, v163
v_fmac_f32 v102, v8, v40
v_fmac_f32 v103, v9, v40
v_fmac_f32 v110, v8, v56
v_fmac_f32 v111, v9, v56
v_lshlrev_b32 v8, 16, v164
v_and_b32 v9, 0xffff0000, v164
v_fmac_f32 v96, v8, v41
v_fmac_f32 v97, v9, v41
v_fmac_f32 v104, v8, v57
v_fmac_f32 v105, v9, v57
v_lshlrev_b32 v8, 16, v165
v_and_b32 v9, 0xffff0000, v165
v_fmac_f32 v98, v8, v41
v_fmac_f32 v99, v9, v41
v_fmac_f32 v106, v8, v57
v_fmac_f32 v107, v9, v57
v_lshlrev_b32 v8, 16, v166
v_and_b32 v9, 0xffff0000, v166
v_fmac_f32 v100, v8, v41
v_fmac_f32 v101, v9, v41
v_fmac_f32 v108, v8, v57
v_fmac_f32 v109, v9, v57
v_lshlrev_b32 v8, 16, v167
v_and_b32 v9, 0xffff0000, v167
v_fmac_f32 v102, v8, v41
v_fmac_f32 v103, v9, v41
v_fmac_f32 v110, v8, v57
v_fmac_f32 v111, v9, v57
v_lshlrev_b32 v8, 16, v168
v_and_b32 v9, 0xffff0000, v168
v_fmac_f32 v96, v8, v42
v_fmac_f32 v97, v9, v42
v_fmac_f32 v104, v8, v58
v_fmac_f32 v105, v9, v58
v_lshlrev_b32 v8, 16, v169
v_and_b32 v9, 0xffff0000, v169
v_fmac_f32 v98, v8, v42
v_fmac_f32 v99, v9, v42
v_fmac_f32 v106, v8, v58
v_fmac_f32 v107, v9, v58
v_lshlrev_b32 v8, 16, v170
v_and_b32 v9, 0xffff0000, v170
v_fmac_f32 v100, v8, v42
v_fmac_f32 v101, v9, v42
v_fmac_f32 v108, v8, v58
v_fmac_f32 v109, v9, v58
v_lshlrev_b32 v8, 16, v171
v_and_b32 v9, 0xffff0000, v171
v_fmac_f32 v102, v8, v42
v_fmac_f32 v103, v9, v42
v_fmac_f32 v110, v8, v58
v_fmac_f32 v111, v9, v58
v_lshlrev_b32 v8, 16, v172
v_and_b32 v9, 0xffff0000, v172
v_fmac_f32 v96, v8, v43
v_fmac_f32 v97, v9, v43
v_fmac_f32 v104, v8, v59
v_fmac_f32 v105, v9, v59
v_lshlrev_b32 v8, 16, v173
v_and_b32 v9, 0xffff0000, v173
v_fmac_f32 v98, v8, v43
v_fmac_f32 v99, v9, v43
v_fmac_f32 v106, v8, v59
v_fmac_f32 v107, v9, v59
v_lshlrev_b32 v8, 16, v174
v_and_b32 v9, 0xffff0000, v174
v_fmac_f32 v100, v8, v43
v_fmac_f32 v101, v9, v43
v_fmac_f32 v108, v8, v59
v_fmac_f32 v109, v9, v59
v_lshlrev_b32 v8, 16, v175
v_and_b32 v9, 0xffff0000, v175
v_fmac_f32 v102, v8, v43
v_fmac_f32 v103, v9, v43
v_fmac_f32 v110, v8, v59
v_fmac_f32 v111, v9, v59
v_lshlrev_b32 v8, 16, v176
v_and_b32 v9, 0xffff0000, v176
v_fmac_f32 v96, v8, v44
v_fmac_f32 v97, v9, v44
v_fmac_f32 v104, v8, v60
v_fmac_f32 v105, v9, v60
v_lshlrev_b32 v8, 16, v177
v_and_b32 v9, 0xffff0000, v177
v_fmac_f32 v98, v8, v44
v_fmac_f32 v99, v9, v44
v_fmac_f32 v106, v8, v60
v_fmac_f32 v107, v9, v60
v_lshlrev_b32 v8, 16, v178
v_and_b32 v9, 0xffff0000, v178
v_fmac_f32 v100, v8, v44
v_fmac_f32 v101, v9, v44
v_fmac_f32 v108, v8, v60
v_fmac_f32 v109, v9, v60
v_lshlrev_b32 v8, 16, v179
v_and_b32 v9, 0xffff0000, v179
v_fmac_f32 v102, v8, v44
v_fmac_f32 v103, v9, v44
v_fmac_f32 v110, v8, v60
v_fmac_f32 v111, v9, v60
v_lshlrev_b32 v8, 16, v180
v_and_b32 v9, 0xffff0000, v180
v_fmac_f32 v96, v8, v45
v_fmac_f32 v97, v9, v45
v_fmac_f32 v104, v8, v61
v_fmac_f32 v105, v9, v61
v_lshlrev_b32 v8, 16, v181
v_and_b32 v9, 0xffff0000, v181
v_fmac_f32 v98, v8, v45
v_fmac_f32 v99, v9, v45
v_fmac_f32 v106, v8, v61
v_fmac_f32 v107, v9, v61
v_lshlrev_b32 v8, 16, v182
v_and_b32 v9, 0xffff0000, v182
v_fmac_f32 v100, v8, v45
v_fmac_f32 v101, v9, v45
v_fmac_f32 v108, v8, v61
v_fmac_f32 v109, v9, v61
v_lshlrev_b32 v8, 16, v183
v_and_b32 v9, 0xffff0000, v183
v_fmac_f32 v102, v8, v45
v_fmac_f32 v103, v9, v45
v_fmac_f32 v110, v8, v61
v_fmac_f32 v111, v9, v61
v_lshlrev_b32 v8, 16, v184
v_and_b32 v9, 0xffff0000, v184
v_fmac_f32 v96, v8, v46
v_fmac_f32 v97, v9, v46
v_fmac_f32 v104, v8, v62
v_fmac_f32 v105, v9, v62
v_lshlrev_b32 v8, 16, v185
v_and_b32 v9, 0xffff0000, v185
v_fmac_f32 v98, v8, v46
v_fmac_f32 v99, v9, v46
v_fmac_f32 v106, v8, v62
v_fmac_f32 v107, v9, v62
v_lshlrev_b32 v8, 16, v186
v_and_b32 v9, 0xffff0000, v186
v_fmac_f32 v100, v8, v46
v_fmac_f32 v101, v9, v46
v_fmac_f32 v108, v8, v62
v_fmac_f32 v109, v9, v62
v_lshlrev_b32 v8, 16, v187
v_and_b32 v9, 0xffff0000, v187
v_fmac_f32 v102, v8, v46
v_fmac_f32 v103, v9, v46
v_fmac_f32 v110, v8, v62
v_fmac_f32 v111, v9, v62
v_lshlrev_b32 v8, 16, v188
v_and_b32 v9, 0xffff0000, v188
v_fmac_f32 v96, v8, v47
v_fmac_f32 v97, v9, v47
v_fmac_f32 v104, v8, v63
v_fmac_f32 v105, v9, v63
v_lshlrev_b32 v8, 16, v189
v_and_b32 v9, 0xffff0000, v189
v_fmac_f32 v98, v8, v47
v_fmac_f32 v99, v9, v47
v_fmac_f32 v106, v8, v63
v_fmac_f32 v107, v9, v63
v_lshlrev_b32 v8, 16, v190
v_and_b32 v9, 0xffff0000, v190
v_fmac_f32 v100, v8, v47
v_fmac_f32 v101, v9, v47
v_fmac_f32 v108, v8, v63
v_fmac_f32 v109, v9, v63
v_lshlrev_b32 v8, 16, v191
v_and_b32 v9, 0xffff0000, v191
v_fmac_f32 v102, v8, v47
v_fmac_f32 v103, v9, v47
v_fmac_f32 v110, v8, v63
v_fmac_f32 v111, v9, v63
v_lshlrev_b32 v8, 10, v7
v_and_b32 v9, 31, v1
v_lshl_add_u32 v8, v9, 5, v8
v_add_u32 v8, s11, v8
ds_write_b128 v8, v[96:99] offset:0
ds_write_b128 v8, v[100:103] offset:16
ds_write_b128 v8, v[104:107] offset:2048
ds_write_b128 v8, v[108:111] offset:2064
s_waitcnt lgkmcnt(0)
s_barrier
v_and_b32 v8, 255, v0
v_lshlrev_b32 v8, 2, v8
v_lshrrev_b32 v9, 8, v0
v_lshl_add_u32 v8, v9, 11, v8
ds_read_b32 v32, v8 offset:0
ds_read_b32 v33, v8 offset:1024
ds_read_b32 v34, v8 offset:8192
ds_read_b32 v35, v8 offset:9216
ds_read_b32 v36, v8 offset:16384
ds_read_b32 v37, v8 offset:17408
ds_read_b32 v38, v8 offset:24576
ds_read_b32 v39, v8 offset:25600
ds_read_b32 v40, v8 offset:32768
ds_read_b32 v41, v8 offset:33792
ds_read_b32 v42, v8 offset:40960
ds_read_b32 v43, v8 offset:41984
ds_read_b32 v44, v8 offset:49152
ds_read_b32 v45, v8 offset:50176
ds_read_b32 v46, v8 offset:57344
ds_read_b32 v47, v8 offset:58368
s_waitcnt lgkmcnt(0)
v_add_f32 v32, v32, v40
v_add_f32 v33, v33, v41
v_add_f32 v34, v34, v42
v_add_f32 v35, v35, v43
v_add_f32 v36, v36, v44
v_add_f32 v37, v37, v45
v_add_f32 v38, v38, v46
v_add_f32 v39, v39, v47
v_add_f32 v32, v32, v36
v_add_f32 v33, v33, v37
v_add_f32 v34, v34, v38
v_add_f32 v35, v35, v39
v_add_f32 v32, v32, v34
v_add_f32 v33, v33, v35
v_add_f32 v32, v32, v33
s_lshl_b32 s10, s9, 11
s_add_u32 s10, s10, 409600
v_lshlrev_b32 v8, 2, v0
buffer_store_dword v32, v8, s[56:59], s10 offen sc1
s_waitcnt vmcnt(0)
s_barrier
s_cmp_lg_u32 s3, 0
s_cbranch_scc1 L_sg_c
v_mov_b32 v10, s94
v_mov_b32 v11, s95
s_lshl_b32 s10, s9, 7
s_add_u32 s10, s10, 0xee000
v_mov_b32 v9, 0
s_mov_b64 exec, 1
buffer_store_dwordx2 v[10:11], v9, s[56:59], s10 offen sc1
s_mov_b64 exec, -1
L_sg_c:
s_branch L_end
L_F1:
s_and_b32 s5, s96, 1
s_lshr_b32 s6, s96, 3
s_bfe_u32 s7, s96, 0x20001
s_mov_b32 s52, s38
s_mov_b32 s53, s39
s_mov_b32 s54, 0xe00
s_mov_b32 s55, 0x20000
v_mov_b32 v9, 0
ds_read_b32 v26, v9 offset:16896
s_waitcnt lgkmcnt(0)
s_cmp_ge_u32 s3, 4
s_cbranch_scc1 L_F1_nd
s_and_b32 s68, s96, 1
s_lshr_b32 s69, s96, 3
s_bfe_u32 s70, s96, 0x20001
s_movk_i32 s10, 4682
v_mul_lo_u32 v30, v1, s10
v_lshrrev_b32 v30, 16, v30
v_mul_u32_u24 v31, 14, v30
v_sub_u32 v31, v1, v31
v_mul_u32_u24 v30, 896, v30
v_lshl_add_u32 v30, v31, 4, v30
s_lshl_b32 s10, s69, 9
s_lshl_b32 s11, s3, 6
s_add_u32 s10, s10, s11
s_mul_i32 s10, s10, 896
s_mul_i32 s11, s70, 224
s_add_u32 s10, s10, s11
s_cmp_eq_u32 s68, 1
s_cselect_b32 s44, s36, s24
s_cselect_b32 s45, s37, s25
s_mov_b32 s46, 0x380000
s_mov_b32 s47, 0x20000
s_mul_i32 s11, s3, 64*224
s_add_u32 s11, s11, 40960
s_mov_b32 exec_hi, 0x00ffffff
s_mov_b32 m0, s11
s_nop 0
buffer_load_dwordx4 v30, s[44:47], s10 offen nt lds
s_add_u32 s10, s10, 3584
s_add_u32 s11, s11, 896
s_mov_b32 m0, s11
s_nop 0
buffer_load_dwordx4 v30, s[44:47], s10 offen nt lds
s_add_u32 s10, s10, 3584
s_add_u32 s11, s11, 896
s_mov_b32 m0, s11
s_nop 0
buffer_load_dwordx4 v30, s[44:47], s10 offen nt lds
s_add_u32 s10, s10, 3584
s_add_u32 s11, s11, 896
s_mov_b32 m0, s11
s_nop 0
buffer_load_dwordx4 v30, s[44:47], s10 offen nt lds
s_add_u32 s10, s10, 3584
s_add_u32 s11, s11, 896
s_mov_b32 m0, s11
s_nop 0
buffer_load_dwordx4 v30, s[44:47], s10 offen nt lds
s_add_u32 s10, s10, 3584
s_add_u32 s11, s11, 896
s_mov_b32 m0, s11
s_nop 0
buffer_load_dwordx4 v30, s[44:47], s10 offen nt lds
s_add_u32 s10, s10, 3584
s_add_u32 s11, s11, 896
s_mov_b32 m0, s11
s_nop 0
buffer_load_dwordx4 v30, s[44:47], s10 offen nt lds
s_add_u32 s10, s10, 3584
s_add_u32 s11, s11, 896
s_mov_b32 m0, s11
s_nop 0
buffer_load_dwordx4 v30, s[44:47], s10 offen nt lds
s_add_u32 s10, s10, 3584
s_add_u32 s11, s11, 896
s_mov_b32 m0, s11
s_nop 0
buffer_load_dwordx4 v30, s[44:47], s10 offen nt lds
s_add_u32 s10, s10, 3584
s_add_u32 s11, s11, 896
s_mov_b32 m0, s11
s_nop 0
buffer_load_dwordx4 v30, s[44:47], s10 offen nt lds
s_add_u32 s10, s10, 3584
s_add_u32 s11, s11, 896
s_mov_b32 m0, s11
s_nop 0
buffer_load_dwordx4 v30, s[44:47], s10 offen nt lds
s_add_u32 s10, s10, 3584
s_add_u32 s11, s11, 896
s_mov_b32 m0, s11
s_nop 0
buffer_load_dwordx4 v30, s[44:47], s10 offen nt lds
s_add_u32 s10, s10, 3584
s_add_u32 s11, s11, 896
s_mov_b32 m0, s11
s_nop 0
buffer_load_dwordx4 v30, s[44:47], s10 offen nt lds
s_add_u32 s10, s10, 3584
s_add_u32 s11, s11, 896
s_mov_b32 m0, s11
s_nop 0
buffer_load_dwordx4 v30, s[44:47], s10 offen nt lds
s_add_u32 s10, s10, 3584
s_add_u32 s11, s11, 896
s_mov_b32 m0, s11
s_nop 0
buffer_load_dwordx4 v30, s[44:47], s10 offen nt lds
s_add_u32 s10, s10, 3584
s_add_u32 s11, s11, 896
s_mov_b32 m0, s11
s_nop 0
buffer_load_dwordx4 v30, s[44:47], s10 offen nt lds
s_mov_b64 exec, -1
L_F1_nd:
s_waitcnt vmcnt(0)
v_min_u32 v8, 13, v2
v_lshlrev_b32 v8, 4, v8
v_mul_u32_u24 v9, 896, v3
v_add_u32 v8, v8, v9
s_mul_i32 s10, s3, 64*224
s_add_u32 s10, s10, 40960
v_add_u32 v8, s10, v8
ds_read_b128 v[128:131], v8 offset:0
ds_read_b128 v[132:135], v8 offset:224
ds_read_b128 v[136:139], v8 offset:448
ds_read_b128 v[140:143], v8 offset:672
ds_read_b128 v[144:147], v8 offset:3584
ds_read_b128 v[148:151], v8 offset:3808
ds_read_b128 v[152:155], v8 offset:4032
ds_read_b128 v[156:159], v8 offset:4256
ds_read_b128 v[160:163], v8 offset:7168
ds_read_b128 v[164:167], v8 offset:7392
ds_read_b128 v[168:171], v8 offset:7616
ds_read_b128 v[172:175], v8 offset:7840
ds_read_b128 v[176:179], v8 offset:10752
ds_read_b128 v[180:183], v8 offset:10976
ds_read_b128 v[184:187], v8 offset:11200
ds_read_b128 v[188:191], v8 offset:11424
s_cmp_eq_u32 s5, 1
s_cbranch_scc1 L_F1_B
s_lshr_b32 s12, s3, 2
s_lshl_b32 s10, s6, 1
s_add_u32 s10, s10, s12
s_mul_i32 s10, s10, 6
s_lshl_b32 s11, s10, 12
s_add_u32 s11, s11, 5242880
v_and_b32 v8, 255, v0
v_lshlrev_b32 v8, 3, v8
v_cmp_le_u32 vcc, 6, v1
v_mov_b32 v9, 90
s_nop 1
v_cndmask_b32 v9, 0, v9, vcc
v_add_u32 v9, v9, v1
v_cmp_gt_u32 vcc, 12, v1
s_nop 1
v_cndmask_b32 v9, 0, v9, vcc
v_lshlrev_b32 v9, 12, v9
s_mov_b32 s12, 0
L_fa_ld:
buffer_load_dwordx4 v[56:59], v9, s[56:59], s11 offen offset:2048 sc1
s_add_u32 s13, s11, 0
buffer_load_dwordx2 v[32:33], v8, s[56:59], s13 offen sc1
s_add_u32 s13, s11, 4096
buffer_load_dwordx2 v[34:35], v8, s[56:59], s13 offen sc1
s_add_u32 s13, s11, 8192
buffer_load_dwordx2 v[36:37], v8, s[56:59], s13 offen sc1
s_add_u32 s13, s11, 12288
buffer_load_dwordx2 v[38:39], v8, s[56:59], s13 offen sc1
s_add_u32 s13, s11, 16384
buffer_load_dwordx2 v[40:41], v8, s[56:59], s13 offen sc1
s_add_u32 s13, s11, 20480
buffer_load_dwordx2 v[42:43], v8, s[56:59], s13 offen sc1
s_add_u32 s13, s11, 393216
buffer_load_dwordx2 v[44:45], v8, s[56:59], s13 offen sc1
s_add_u32 s13, s11, 397312
buffer_load_dwordx2 v[46:47], v8, s[56:59], s13 offen sc1
s_add_u32 s13, s11, 401408
buffer_load_dwordx2 v[48:49], v8, s[56:59], s13 offen sc1
s_add_u32 s13, s11, 405504
buffer_load_dwordx2 v[50:51], v8, s[56:59], s13 offen sc1
s_add_u32 s13, s11, 409600
buffer_load_dwordx2 v[52:53], v8, s[56:59], s13 offen sc1
s_add_u32 s13, s11, 413696
buffer_load_dwordx2 v[54:55], v8, s[56:59], s13 offen sc1
s_cmp_lg_u32 s12, 0
s_cbranch_scc1 L_fa_w
s_waitcnt lgkmcnt(0)
v_perm_b32 v192, v132, v128, s100
v_perm_b32 v193, v140, v136, s100
v_perm_b32 v194, v132, v128, s101
v_perm_b32 v195, v140, v136, s101
v_perm_b32 v196, v133, v129, s100
v_perm_b32 v197, v141, v137, s100
v_perm_b32 v198, v133, v129, s101
v_perm_b32 v199, v141, v137, s101
v_perm_b32 v200, v134, v130, s100
v_perm_b32 v201, v142, v138, s100
v_perm_b32 v202, v134, v130, s101
v_perm_b32 v203, v142, v138, s101
v_perm_b32 v204, v135, v131, s100
v_perm_b32 v205, v143, v139, s100
v_perm_b32 v206, v135, v131, s101
v_perm_b32 v207, v143, v139, s101
v_perm_b32 v208, v148, v144, s100
v_perm_b32 v209, v156, v152, s100
v_perm_b32 v210, v148, v144, s101
v_perm_b32 v211, v156, v152, s101
v_perm_b32 v212, v149, v145, s100
v_perm_b32 v213, v157, v153, s100
v_perm_b32 v214, v149, v145, s101
v_perm_b32 v215, v157, v153, s101
v_perm_b32 v216, v150, v146, s100
v_perm_b32 v217, v158, v154, s100
v_perm_b32 v218, v150, v146, s101
v_perm_b32 v219, v158, v154, s101
v_perm_b32 v220, v151, v147, s100
v_perm_b32 v221, v159, v155, s100
v_perm_b32 v222, v151, v147, s101
v_perm_b32 v223, v159, v155, s101
v_perm_b32 v224, v164, v160, s100
v_perm_b32 v225, v172, v168, s100
v_perm_b32 v226, v164, v160, s101
v_perm_b32 v227, v172, v168, s101
v_perm_b32 v228, v165, v161, s100
v_perm_b32 v229, v173, v169, s100
v_perm_b32 v230, v165, v161, s101
v_perm_b32 v231, v173, v169, s101
v_perm_b32 v232, v166, v162, s100
v_perm_b32 v233, v174, v170, s100
v_perm_b32 v234, v166, v162, s101
v_perm_b32 v235, v174, v170, s101
v_perm_b32 v236, v167, v163, s100
v_perm_b32 v237, v175, v171, s100
v_perm_b32 v238, v167, v163, s101
v_perm_b32 v239, v175, v171, s101
v_perm_b32 v240, v180, v176, s100
v_perm_b32 v241, v188, v184, s100
v_perm_b32 v242, v180, v176, s101
v_perm_b32 v243, v188, v184, s101
v_perm_b32 v244, v181, v177, s100
v_perm_b32 v245, v189, v185, s100
v_perm_b32 v246, v181, v177, s101
v_perm_b32 v247, v189, v185, s101
v_perm_b32 v248, v182, v178, s100
v_perm_b32 v249, v190, v186, s100
v_perm_b32 v250, v182, v178, s101
v_perm_b32 v251, v190, v186, s101
v_perm_b32 v252, v183, v179, s100
v_perm_b32 v253, v191, v187, s100
v_perm_b32 v254, v183, v179, s101
v_perm_b32 v255, v191, v187, s101
L_fa_w:
s_waitcnt vmcnt(0)
v_xor_b32 v12, v57, v26
v_xor_b32 v13, v59, v26
v_or_b32 v12, v12, v13
v_xor_b32 v13, v33, v26
v_or_b32 v12, v12, v13
v_xor_b32 v13, v35, v26
v_or_b32 v12, v12, v13
v_xor_b32 v13, v37, v26
v_or_b32 v12, v12, v13
v_xor_b32 v13, v39, v26
v_or_b32 v12, v12, v13
v_xor_b32 v13, v41, v26
v_or_b32 v12, v12, v13
v_xor_b32 v13, v43, v26
v_or_b32 v12, v12, v13
v_xor_b32 v13, v45, v26
v_or_b32 v12, v12, v13
v_xor_b32 v13, v47, v26
v_or_b32 v12, v12, v13
v_xor_b32 v13, v49, v26
v_or_b32 v12, v12, v13
v_xor_b32 v13, v51, v26
v_or_b32 v12, v12, v13
v_xor_b32 v13, v53, v26
v_or_b32 v12, v12, v13
v_xor_b32 v13, v55, v26
v_or_b32 v12, v12, v13
v_cmp_ne_u32 vcc, 0, v12
s_cmp_eq_u64 vcc, 0
s_cbranch_scc1 L_fa_ok
s_sleep 2
s_add_u32 s12, s12, 1
s_cmp_lt_u32 s12, 0x40000
s_cbranch_scc1 L_fa_ld
L_fa_ok:
v_readlane_b32 s64, v56, 0
v_readlane_b32 s76, v58, 0
v_readlane_b32 s65, v56, 1
v_readlane_b32 s77, v58, 1
v_readlane_b32 s66, v56, 2
v_readlane_b32 s78, v58, 2
v_readlane_b32 s67, v56, 3
v_readlane_b32 s79, v58, 3
v_readlane_b32 s68, v56, 4
v_readlane_b32 s80, v58, 4
v_readlane_b32 s69, v56, 5
v_readlane_b32 s81, v58, 5
v_readlane_b32 s70, v56, 6
v_readlane_b32 s82, v58, 6
v_readlane_b32 s71, v56, 7
v_readlane_b32 s83, v58, 7
v_readlane_b32 s72, v56, 8
v_readlane_b32 s84, v58, 8
v_readlane_b32 s73, v56, 9
v_readlane_b32 s85, v58, 9
v_readlane_b32 s74, v56, 10
v_readlane_b32 s86, v58, 10
v_readlane_b32 s75, v56, 11
v_readlane_b32 s87, v58, 11
s_nop 1
v_mov_b32 v12, s64
v_max_f32 v12, s65, v12
v_max_f32 v12, s66, v12
v_max_f32 v12, s67, v12
v_max_f32 v12, s68, v12
v_max_f32 v12, s69, v12
v_sub_f32 v64, s64, v12
v_mul_f32 v64, s15, v64
v_exp_f32 v64, v64
v_sub_f32 v65, s65, v12
v_mul_f32 v65, s15, v65
v_exp_f32 v65, v65
v_sub_f32 v66, s66, v12
v_mul_f32 v66, s15, v66
v_exp_f32 v66, v66
v_sub_f32 v67, s67, v12
v_mul_f32 v67, s15, v67
v_exp_f32 v67, v67
v_sub_f32 v68, s68, v12
v_mul_f32 v68, s15, v68
v_exp_f32 v68, v68
v_sub_f32 v69, s69, v12
v_mul_f32 v69, s15, v69
v_exp_f32 v69, v69
s_nop 0
v_mul_f32 v13, s76, v64
v_mul_f32 v10, v64, v32
v_fmac_f32 v13, s77, v65
v_fmac_f32 v10, v65, v34
v_fmac_f32 v13, s78, v66
v_fmac_f32 v10, v66, v36
v_fmac_f32 v13, s79, v67
v_fmac_f32 v10, v67, v38
v_fmac_f32 v13, s80, v68
v_fmac_f32 v10, v68, v40
v_fmac_f32 v13, s81, v69
v_fmac_f32 v10, v69, v42
v_rcp_f32 v12, v13
s_nop 0
v_fma_f32 v14, -v13, v12, 1.0
v_fmac_f32 v12, v14, v12
v_mul_f32 v10, v10, v12
v_mov_b32 v12, s70
v_max_f32 v12, s71, v12
v_max_f32 v12, s72, v12
v_max_f32 v12, s73, v12
v_max_f32 v12, s74, v12
v_max_f32 v12, s75, v12
v_sub_f32 v64, s70, v12
v_mul_f32 v64, s15, v64
v_exp_f32 v64, v64
v_sub_f32 v65, s71, v12
v_mul_f32 v65, s15, v65
v_exp_f32 v65, v65
v_sub_f32 v66, s72, v12
v_mul_f32 v66, s15, v66
v_exp_f32 v66, v66
v_sub_f32 v67, s73, v12
v_mul_f32 v67, s15, v67
v_exp_f32 v67, v67
v_sub_f32 v68, s74, v12
v_mul_f32 v68, s15, v68
v_exp_f32 v68, v68
v_sub_f32 v69, s75, v12
v_mul_f32 v69, s15, v69
v_exp_f32 v69, v69
s_nop 0
v_mul_f32 v13, s82, v64
v_mul_f32 v11, v64, v44
v_fmac_f32 v13, s83, v65
v_fmac_f32 v11, v65, v46
v_fmac_f32 v13, s84, v66
v_fmac_f32 v11, v66, v48
v_fmac_f32 v13, s85, v67
v_fmac_f32 v11, v67, v50
v_fmac_f32 v13, s86, v68
v_fmac_f32 v11, v68, v52
v_fmac_f32 v13, s87, v69
v_fmac_f32 v11, v69, v54
v_rcp_f32 v12, v13
s_nop 0
v_fma_f32 v14, -v13, v12, 1.0
v_fmac_f32 v12, v14, v12
v_mul_f32 v11, v11, v12
s_branch L_F1_j
L_F1_B:
s_waitcnt lgkmcnt(0)
v_perm_b32 v192, v132, v128, s100
v_perm_b32 v193, v140, v136, s100
v_perm_b32 v194, v132, v128, s101
v_perm_b32 v195, v140, v136, s101
v_perm_b32 v196, v133, v129, s100
v_perm_b32 v197, v141, v137, s100
v_perm_b32 v198, v133, v129, s101
v_perm_b32 v199, v141, v137, s101
v_perm_b32 v200, v134, v130, s100
v_perm_b32 v201, v142, v138, s100
v_perm_b32 v202, v134, v130, s101
v_perm_b32 v203, v142, v138, s101
v_perm_b32 v204, v135, v131, s100
v_perm_b32 v205, v143, v139, s100
v_perm_b32 v206, v135, v131, s101
v_perm_b32 v207, v143, v139, s101
v_perm_b32 v208, v148, v144, s100
v_perm_b32 v209, v156, v152, s100
v_perm_b32 v210, v148, v144, s101
v_perm_b32 v211, v156, v152, s101
v_perm_b32 v212, v149, v145, s100
v_perm_b32 v213, v157, v153, s100
v_perm_b32 v214, v149, v145, s101
v_perm_b32 v215, v157, v153, s101
v_perm_b32 v216, v150, v146, s100
v_perm_b32 v217, v158, v154, s100
v_perm_b32 v218, v150, v146, s101
v_perm_b32 v219, v158, v154, s101
v_perm_b32 v220, v151, v147, s100
v_perm_b32 v221, v159, v155, s100
v_perm_b32 v222, v151, v147, s101
v_perm_b32 v223, v159, v155, s101
v_perm_b32 v224, v164, v160, s100
v_perm_b32 v225, v172, v168, s100
v_perm_b32 v226, v164, v160, s101
v_perm_b32 v227, v172, v168, s101
v_perm_b32 v228, v165, v161, s100
v_perm_b32 v229, v173, v169, s100
v_perm_b32 v230, v165, v161, s101
v_perm_b32 v231, v173, v169, s101
v_perm_b32 v232, v166, v162, s100
v_perm_b32 v233, v174, v170, s100
v_perm_b32 v234, v166, v162, s101
v_perm_b32 v235, v174, v170, s101
v_perm_b32 v236, v167, v163, s100
v_perm_b32 v237, v175, v171, s100
v_perm_b32 v238, v167, v163, s101
v_perm_b32 v239, v175, v171, s101
v_perm_b32 v240, v180, v176, s100
v_perm_b32 v241, v188, v184, s100
v_perm_b32 v242, v180, v176, s101
v_perm_b32 v243, v188, v184, s101
v_perm_b32 v244, v181, v177, s100
v_perm_b32 v245, v189, v185, s100
v_perm_b32 v246, v181, v177, s101
v_perm_b32 v247, v189, v185, s101
v_perm_b32 v248, v182, v178, s100
v_perm_b32 v249, v190, v186, s100
v_perm_b32 v250, v182, v178, s101
v_perm_b32 v251, v190, v186, s101
v_perm_b32 v252, v183, v179, s100
v_perm_b32 v253, v191, v187, s100
v_perm_b32 v254, v183, v179, s101
v_perm_b32 v255, v191, v187, s101
s_lshl_b32 s12, s6, 1
s_cmp_lg_u32 s3, 0
s_cbranch_scc1 L_pw_fb
v_lshlrev_b32 v9, 7, v1
s_mov_b32 s10, 0xee000
s_lshl_b32 s11, s12, 9
s_add_u32 s10, s10, s11
s_mov_b32 s11, 0
s_mov_b64 exec, 0xff
L_pl_fb:
buffer_load_dwordx2 v[10:11], v9, s[56:59], s10 offen sc1
s_waitcnt vmcnt(0)
v_cmp_ne_u64 vcc, s[94:95], v[10:11]
s_cmp_eq_u64 vcc, 0
s_cbranch_scc1 L_pd_fb
s_sleep 24
s_add_u32 s11, s11, 1
s_cmp_lt_u32 s11, 0x40000
s_cbranch_scc1 L_pl_fb
L_pd_fb:
s_mov_b64 exec, -1
L_pw_fb:
s_barrier
s_lshr_b32 s12, s3, 2
s_lshl_b32 s10, s6, 1
s_add_u32 s10, s10, s12
s_lshl_b32 s11, s10, 13
s_add_u32 s11, s11, 409600
v_and_b32 v8, 255, v0
v_lshlrev_b32 v8, 2, v8
s_add_u32 s13, s11, 0
buffer_load_dword v64, v8, s[56:59], s13 offen offset:0 sc1
buffer_load_dword v68, v8, s[56:59], s13 offen offset:1024 sc1
s_add_u32 s13, s11, 2048
buffer_load_dword v65, v8, s[56:59], s13 offen offset:0 sc1
buffer_load_dword v69, v8, s[56:59], s13 offen offset:1024 sc1
s_add_u32 s13, s11, 4096
buffer_load_dword v66, v8, s[56:59], s13 offen offset:0 sc1
buffer_load_dword v70, v8, s[56:59], s13 offen offset:1024 sc1
s_add_u32 s13, s11, 6144
buffer_load_dword v67, v8, s[56:59], s13 offen offset:0 sc1
buffer_load_dword v71, v8, s[56:59], s13 offen offset:1024 sc1
s_waitcnt vmcnt(0)
v_add_f32 v10, v64, v65
v_add_f32 v12, v66, v67
v_add_f32 v10, v10, v12
v_add_f32 v11, v68, v69
v_add_f32 v12, v70, v71
v_add_f32 v11, v11, v12
L_F1_j:
v_cvt_pk_bf16_f32 v12, v10, v11
v_lshlrev_b32 v8, 1, v0
ds_write_b16 v8, v12 offset:0
ds_write_b16_d16_hi v8, v12 offset:1024
s_waitcnt lgkmcnt(0)
s_barrier
v_and_b32 v8, 1, v2
v_lshlrev_b32 v8, 10, v8
v_lshl_add_u32 v8, v3, 3, v8
s_lshl_b32 s10, s3, 7
v_add_u32 v8, s10, v8
ds_read_b64 v[64:65], v8 offset:0
ds_read_b64 v[66:67], v8 offset:32
ds_read_b64 v[68:69], v8 offset:64
ds_read_b64 v[70:71], v8 offset:96
s_waitcnt lgkmcnt(0)
v_mfma_f32_16x16x16_bf16 v[96:99], v[64:65], v[192:193], 0
v_mfma_f32_16x16x16_bf16 v[100:103], v[64:65], v[194:195], 0
v_mfma_f32_16x16x16_bf16 v[104:107], v[64:65], v[196:197], 0
v_mfma_f32_16x16x16_bf16 v[108:111], v[64:65], v[198:199], 0
v_mfma_f32_16x16x16_bf16 v[112:115], v[64:65], v[200:201], 0
v_mfma_f32_16x16x16_bf16 v[116:119], v[64:65], v[202:203], 0
v_mfma_f32_16x16x16_bf16 v[120:123], v[64:65], v[204:205], 0
v_mfma_f32_16x16x16_bf16 v[124:127], v[64:65], v[206:207], 0
v_mfma_f32_16x16x16_bf16 v[96:99], v[66:67], v[208:209], v[96:99]
v_mfma_f32_16x16x16_bf16 v[100:103], v[66:67], v[210:211], v[100:103]
v_mfma_f32_16x16x16_bf16 v[104:107], v[66:67], v[212:213], v[104:107]
v_mfma_f32_16x16x16_bf16 v[108:111], v[66:67], v[214:215], v[108:111]
v_mfma_f32_16x16x16_bf16 v[112:115], v[66:67], v[216:217], v[112:115]
v_mfma_f32_16x16x16_bf16 v[116:119], v[66:67], v[218:219], v[116:119]
v_mfma_f32_16x16x16_bf16 v[120:123], v[66:67], v[220:221], v[120:123]
v_mfma_f32_16x16x16_bf16 v[124:127], v[66:67], v[222:223], v[124:127]
v_mfma_f32_16x16x16_bf16 v[96:99], v[68:69], v[224:225], v[96:99]
v_mfma_f32_16x16x16_bf16 v[100:103], v[68:69], v[226:227], v[100:103]
v_mfma_f32_16x16x16_bf16 v[104:107], v[68:69], v[228:229], v[104:107]
v_mfma_f32_16x16x16_bf16 v[108:111], v[68:69], v[230:231], v[108:111]
v_mfma_f32_16x16x16_bf16 v[112:115], v[68:69], v[232:233], v[112:115]
v_mfma_f32_16x16x16_bf16 v[116:119], v[68:69], v[234:235], v[116:119]
v_mfma_f32_16x16x16_bf16 v[120:123], v[68:69], v[236:237], v[120:123]
v_mfma_f32_16x16x16_bf16 v[124:127], v[68:69], v[238:239], v[124:127]
v_mfma_f32_16x16x16_bf16 v[96:99], v[70:71], v[240:241], v[96:99]
v_mfma_f32_16x16x16_bf16 v[100:103], v[70:71], v[242:243], v[100:103]
v_mfma_f32_16x16x16_bf16 v[104:107], v[70:71], v[244:245], v[104:107]
v_mfma_f32_16x16x16_bf16 v[108:111], v[70:71], v[246:247], v[108:111]
v_mfma_f32_16x16x16_bf16 v[112:115], v[70:71], v[248:249], v[112:115]
v_mfma_f32_16x16x16_bf16 v[116:119], v[70:71], v[250:251], v[116:119]
v_mfma_f32_16x16x16_bf16 v[120:123], v[70:71], v[252:253], v[120:123]
v_mfma_f32_16x16x16_bf16 v[124:127], v[70:71], v[254:255], v[124:127]
s_nop 7
s_nop 7
v_mov_b32 v32, v96
v_mov_b32 v40, v97
v_mov_b32 v33, v100
v_mov_b32 v41, v101
v_mov_b32 v34, v104
v_mov_b32 v42, v105
v_mov_b32 v35, v108
v_mov_b32 v43, v109
v_mov_b32 v36, v112
v_mov_b32 v44, v113
v_mov_b32 v37, v116
v_mov_b32 v45, v117
v_mov_b32 v38, v120
v_mov_b32 v46, v121
v_mov_b32 v39, v124
v_mov_b32 v47, v125
s_lshl_b32 s10, s3, 10
v_lshlrev_b32 v8, 5, v2
v_add_u32 v8, s10, v8
s_mov_b64 exec, 0x3fff
ds_write_b128 v8, v[32:35] offset:4096
ds_write_b128 v8, v[36:39] offset:4112
ds_write_b128 v8, v[40:43] offset:4608
ds_write_b128 v8, v[44:47] offset:4624
s_mov_b64 exec, -1
s_waitcnt lgkmcnt(0)
s_barrier
s_cmp_ge_u32 s3, 4
s_cbranch_scc1 L_end
v_and_b32 v12, 127, v0
v_lshrrev_b32 v13, 7, v0
v_lshlrev_b32 v8, 2, v0
ds_read_b32 v32, v8 offset:4096
ds_read_b32 v33, v8 offset:5120
ds_read_b32 v34, v8 offset:6144
ds_read_b32 v35, v8 offset:7168
ds_read_b32 v36, v8 offset:8192
ds_read_b32 v37, v8 offset:9216
ds_read_b32 v38, v8 offset:10240
ds_read_b32 v39, v8 offset:11264
s_waitcnt lgkmcnt(0)
v_add_f32 v32, v32, v36
v_add_f32 v33, v33, v37
v_add_f32 v34, v34, v38
v_add_f32 v35, v35, v39
v_add_f32 v32, v32, v34
v_add_f32 v33, v33, v35
v_add_f32 v32, v32, v33
s_lshl_b32 s12, s5, 2
s_add_u32 s12, s12, s7
s_lshl_b32 s10, s12, 3
s_add_u32 s10, s10, s6
s_lshl_b32 s10, s10, 11
s_add_u32 s10, s10, 589824
v_lshlrev_b32 v14, 3, v0
v_mov_b32 v33, v26
buffer_store_dwordx2 v[32:33], v14, s[56:59], s10 offen sc1
s_cmp_lg_u32 s6, 0
s_cbranch_scc1 L_end
s_mov_b32 s12, 0
s_add_u32 s11, s10, 0x1000
s_add_u32 s13, s10, 0x2000
s_add_u32 s93, s10, 0x3000
L_f2_ld:
buffer_load_dwordx2 v[66:67], v14, s[56:59], s10 offen offset:2048 sc1
buffer_load_dwordx2 v[68:69], v14, s[56:59], s11 offen offset:0 sc1
buffer_load_dwordx2 v[70:71], v14, s[56:59], s11 offen offset:2048 sc1
buffer_load_dwordx2 v[72:73], v14, s[56:59], s13 offen offset:0 sc1
buffer_load_dwordx2 v[74:75], v14, s[56:59], s13 offen offset:2048 sc1
buffer_load_dwordx2 v[76:77], v14, s[56:59], s93 offen offset:0 sc1
buffer_load_dwordx2 v[78:79], v14, s[56:59], s93 offen offset:2048 sc1
s_waitcnt vmcnt(0)
v_xor_b32 v8, v67, v26
v_xor_b32 v9, v69, v26
v_or_b32 v8, v8, v9
v_xor_b32 v9, v71, v26
v_or_b32 v8, v8, v9
v_xor_b32 v9, v73, v26
v_or_b32 v8, v8, v9
v_xor_b32 v9, v75, v26
v_or_b32 v8, v8, v9
v_xor_b32 v9, v77, v26
v_or_b32 v8, v8, v9
v_xor_b32 v9, v79, v26
v_or_b32 v8, v8, v9
v_cmp_ne_u32 vcc, 0, v8
s_cmp_eq_u64 vcc, 0
s_cbranch_scc1 L_f2_ok
s_sleep 2
s_add_u32 s12, s12, 1
s_cmp_lt_u32 s12, 0x40000
s_cbranch_scc1 L_f2_ld
L_f2_ok:
v_mov_b32 v33, v66
v_mov_b32 v34, v68
v_mov_b32 v35, v70
v_mov_b32 v36, v72
v_mov_b32 v37, v74
v_mov_b32 v38, v76
v_mov_b32 v39, v78
v_add_f32 v32, v32, v36
v_add_f32 v33, v33, v37
v_add_f32 v34, v34, v38
v_add_f32 v35, v35, v39
v_add_f32 v32, v32, v34
v_add_f32 v33, v33, v35
v_add_f32 v32, v32, v33
v_cvt_pk_bf16_f32 v32, v32, v32
s_mul_i32 s10, s5, 448
s_mul_i32 s11, s7, 112
s_add_u32 s10, s10, s11
s_lshl_b32 s10, s10, 1
v_mul_u32_u24 v8, 896, v13
v_add_u32 v8, v8, v12
v_lshlrev_b32 v8, 1, v8
v_cmp_gt_u32 vcc, 112, v12
s_and_saveexec_b64 s[12:13], vcc
buffer_store_short v32, v8, s[52:55], s10 offen
s_branch L_end
L_end:
L_exit:
s_endpgm
.section .rodata,"a"
.p2align 6
.amdhsa_kernel concat_heads__mha_block_cached__compressed_kv_cla__decode_kernel
  .amdhsa_next_free_vgpr 256
  .amdhsa_next_free_sgpr 102
  .amdhsa_accum_offset 256
  .amdhsa_group_segment_fixed_size 0
  .amdhsa_kernarg_size 112
  .amdhsa_user_sgpr_count 2
  .amdhsa_user_sgpr_kernarg_segment_ptr 1
  .amdhsa_system_sgpr_workgroup_id_x 1
.end_amdhsa_kernel
```
